```python
import torch

def _softmax(x, axis=-1):
    return torch.softmax(x, dim=axis)
def _gelu(x):
    return torch.nn.functional.gelu(x, approximate="tanh")
def _silu(x):
    return torch.nn.functional.silu(x)
def _sigmoid(x):
    return torch.sigmoid(x)
def _layernorm(x, axis=-1, eps=1e-5):
    m = x.mean(dim=axis, keepdim=True)
    v = x.var(dim=axis, keepdim=True, unbiased=False)
    return (x - m) / torch.sqrt(v + eps)
def _scatter_add(tgt, idx, src, axis=0):
    return tgt.clone().index_add_(axis, idx, src)
def _segment_sum(src, seg, n):
    out = torch.zeros((n,) + src.shape[1:], dtype=src.dtype)
    return out.index_add_(0, seg, src)
def _pad(x, pw):
    flat = tuple(v for pair in reversed(pw) for v in pair)
    return torch.nn.functional.pad(x, flat)

kernel_name = 'parallel_sum__ssm_conv_s4d__glu_gated_swiglu__prompt'

def setup_inputs():

    _w = (lambda a: (lambda t: t.to(torch.bfloat16) if t.is_floating_point() else t)(torch.as_tensor(a)))
    def _A_setup():
        Bsz, L, D, N = 1, 2048, 640, 128
        return {
            "u": _w((lambda *s: torch.randn(*s, dtype=torch.bfloat16) * 0.05)(Bsz, L, D)),
            "log_A_real": _w((lambda *s: torch.randn(*s, dtype=torch.bfloat16) * 3.2)(D, N) * 0.5),
            "A_imag": _w((lambda *s: torch.randn(*s, dtype=torch.bfloat16) * 0.05)(D, N) * 3.14),
            "C_real": _w((lambda *s: torch.randn(*s, dtype=torch.bfloat16) * 0.2)(D, N) / N ** 0.5),
            "C_imag": _w((lambda *s: torch.randn(*s, dtype=torch.bfloat16) * 0.2)(D, N) / N ** 0.5),
            "log_dt": _w((lambda *s: torch.randn(*s, dtype=torch.bfloat16) * 0.05)(D) * 0.5 - 4.0),
            "D_skip": _w((lambda *s: torch.randn(*s, dtype=torch.bfloat16) * 0.05)(D)),
        }
    _A_in = _A_setup()

    def _B_setup():
        B, S, D, F = 1, 2048, 640, 1728
        return {
            "x": _w((lambda *s: torch.randn(*s, dtype=torch.bfloat16) * 0.05)(B, S, D)),
            "w1": _w((lambda *s: torch.randn(*s, dtype=torch.bfloat16) * 0.4)(D, F) * (2.0 / D) ** 0.5),
            "w3": _w((lambda *s: torch.randn(*s, dtype=torch.bfloat16) * 0.4)(D, F) * (2.0 / D) ** 0.5),
            "w2": _w((lambda *s: torch.randn(*s, dtype=torch.bfloat16) * 0.4)(F, D) * (2.0 / F) ** 0.5),
        }
    _B_in = _B_setup()

    return {
        "A_u": _A_in["u"],
        "A_log_A_real": _A_in["log_A_real"],
        "A_A_imag": _A_in["A_imag"],
        "A_C_real": _A_in["C_real"],
        "A_C_imag": _A_in["C_imag"],
        "A_log_dt": _A_in["log_dt"],
        "A_D_skip": _A_in["D_skip"],
        "B_x": _B_in["x"],
        "B_w1": _B_in["w1"],
        "B_w3": _B_in["w3"],
        "B_w2": _B_in["w2"],
    }

def reference(A_u, A_log_A_real, A_A_imag, A_C_real, A_C_imag, A_log_dt, A_D_skip, B_x, B_w1, B_w3, B_w2):
    def _A_ref(u, log_A_real, A_imag, C_real, C_imag, log_dt, D_skip):
        L = u.shape[1]
        dt = torch.exp(log_dt)
        A = -torch.exp(log_A_real) + 1j * A_imag
        C = (C_real + 1j * C_imag) * dt[:, None]
        pos = (lambda x, dt: x.to(dt))(torch.arange(L), log_dt.dtype)
        P = torch.exp((A * dt[:, None])[:, :, None] * pos[None, None, :])
        K = 2.0 * torch.einsum("dn,dnl->dl", C, P).real
        L2 = 2 * L
        u_t = (lambda x, *d: x.permute(*d))(u, 0, 2, 1)
        Kf = (lambda x, *a, **k: torch.fft.rfft(x.float(), *a, **k))(K, L2)
        Uf = (lambda x, *a, **k: torch.fft.rfft(x.float(), *a, **k))(u_t, L2)
        y = (lambda x, *a, **k: torch.fft.irfft(x, *a, **k).to(torch.bfloat16))(Uf * Kf[None, :, :], L2)[:, :, :L]
        y = (lambda x, *d: x.permute(*d))(y, 0, 2, 1)
        return y + u * D_skip[None, None, :]

    def _B_ref(x, w1, w3, w2):
        gate = torch.einsum("bsd,df->bsf", x, w1)
        up = torch.einsum("bsd,df->bsf", x, w3)
        h = _silu(gate) * up
        out = torch.einsum("bsf,fd->bsd", h, w2)
        return out

    x = A_u
    xn = _layernorm(x, axis=-1)
    return x + _A_ref(xn, A_log_A_real, A_A_imag, A_C_real, A_C_imag, A_log_dt, A_D_skip) + _B_ref(xn, B_w1, B_w3, B_w2)
```

```asm
; @launch grid=(256,1,1) block=(512,1,1) lds=163840
.amdgcn_target "amdgcn-amd-amdhsa--gfx950"
.text
.globl parallel_sum__ssm_conv_s4d__glu_gated_swiglu__prompt_kernel
.p2align 8
.type parallel_sum__ssm_conv_s4d__glu_gated_swiglu__prompt_kernel,@function
parallel_sum__ssm_conv_s4d__glu_gated_swiglu__prompt_kernel:
    s_cmp_ge_u32 s2, 256
    s_cbranch_scc1 L_exit
    s_load_dwordx16 s[16:31], s[0:1], 0
    s_load_dwordx8 s[32:39], s[0:1], 64
    s_load_dwordx4 s[40:43], s[0:1], 96
    s_cmp_ge_u32 s2, 8
    s_cbranch_scc1 L_nopf
    s_getpc_b64 s[8:9]
L_pc:
    v_lshlrev_b32 v2, 7, v0
    v_min_u32 v2, L_code_end-L_pc-4, v2
    global_load_dword v255, v2, s[8:9]
L_nopf:
    v_lshrrev_b32 v1, 6, v0
    v_and_b32 v0, 63, v0
    v_readfirstlane_b32 s3, v1
    s_mov_b32 s89, 0
    s_and_b32 s4, s2, 7
    s_lshr_b32 s5, s2, 3
    s_lshr_b32 s7, s4, 1
    s_lshr_b32 s6, s5, 2
    s_lshl3_add_u32 s90, s7, s6
    s_and_b32 s8, s4, 1
    s_and_b32 s6, s5, 3
    s_lshl2_add_u32 s91, s8, s6
    s_lshl2_add_u32 s6, s8, s7
    s_lshl_b32 s6, s6, 5
    s_add_u32 s88, s6, s5
    s_cmp_lt_u32 s5, 5
    s_cbranch_scc1 L_aux
    s_sub_u32 s5, s5, 5
    s_mul_i32 s94, s4, 27
    s_add_u32 s94, s94, s5
    s_lshr_b32 s6, s4, 1
    s_mul_i32 s6, s6, 27
    s_add_u32 s6, s6, s5
    s_lshr_b32 s93, s6, 2
    s_and_b32 s6, s6, 3
    s_and_b32 s7, s4, 1
    s_lshl2_add_u32 s92, s7, s6
    s_mov_b32 s83, 0
    s_cmp_ge_u32 s3, 4
    s_cbranch_scc1 L_help
    s_and_b32 s8, s3, 1
    s_lshr_b32 s56, s3, 1
    s_mov_b32 s57, s56
    s_lshl1_add_u32 s72, s94, s8
    s_lshl_b32 s9, s72, 1
    v_mov_b32 v1, s9
    s_lshl_b32 s9, s72, 8
    v_lshl_add_u32 v2, v0, 1, s9
    s_lshl_b32 s9, s56, 7
    v_add_u32 v2, s9, v2
    v_mov_b32 v10, 0
    v_mov_b32 v11, 0
    v_mov_b32 v12, 0
    v_mov_b32 v13, 0
    v_mov_b32 v14, 0
    v_mov_b32 v18, 0
    s_waitcnt lgkmcnt(0)
    global_load_short_d16_hi v14, v1, s[26:27]
    global_load_short_d16_hi v10, v2, s[18:19]
    global_load_short_d16_hi v11, v2, s[20:21]
    global_load_short_d16_hi v12, v2, s[22:23]
    global_load_short_d16_hi v13, v2, s[24:25]
    global_load_short_d16_hi v18, v1, s[28:29]
    v_lshrrev_b32 v220, 5, v0
    v_and_b32 v221, 31, v0
    v_mul_u32_u24 v222, 1280, v220
    v_lshl_add_u32 v222, v221, 3, v222
    s_lshl2_add_u32 s9, s88, s3
    s_mul_i32 s9, s9, 2560
    v_add_u32 v222, s9, v222
    global_load_dwordx2 v[208:209], v222, s[16:17] offset:0
    global_load_dwordx2 v[210:211], v222, s[16:17] offset:256
    global_load_dwordx2 v[212:213], v222, s[16:17] offset:512
    global_load_dwordx2 v[214:215], v222, s[16:17] offset:768
    global_load_dwordx2 v[216:217], v222, s[16:17] offset:1024
    s_mul_i32 s73, s8, 15104
    s_mul_i32 s74, s3, 4352
    s_add_u32 s74, s74, 80896
    s_mul_i32 s75, s8, 1536
    s_add_u32 s75, s75, 158720
    s_mov_b32 s78, s56
    v_and_b32 v246, 15, v0
    v_lshrrev_b32 v247, 4, v0
    v_lshlrev_b32 v243, 4, v0
    v_and_b32 v245, 3, v0
    v_bfe_u32 v244, v0, 2, 2
    v_sub_u32 v232, 4, v244
    v_and_b32 v232, 3, v232
    v_mul_u32_u24 v232, 2624, v232
    v_lshl_add_u32 v232, v245, 3, v232
    v_min_u32 v233, 1, v244
    v_lshl_add_u32 v233, v247, 1, v233
    v_lshlrev_b32 v233, 3, v233
    s_lshl_b32 s76, s78, 8
    s_add_u32 s77, s73, s76
    s_sub_u32 s76, s73, s76
    s_add_u32 s77, s77, 56
    s_add_u32 s76, s76, 10976
    v_sub_u32 v232, v232, v233
    v_add_u32 v232, s77, v232
    v_lshlrev_b32 v236, 5, v246
    v_lshl_add_u32 v233, v247, 4, v236
    v_add_u32 v233, s76, v233
    v_lshlrev_b32 v249, 3, v247
    v_sub_u32 v249, v246, v249
    s_lshl_b32 s76, s78, 6
    s_add_u32 s76, s76, 16
    v_add_u32 v249, s76, v249
    v_and_b32 v235, 1, v249
    v_xor_b32 v235, 1, v235
    v_lshlrev_b32 v235, 4, v235
    v_lshrrev_b32 v249, 1, v249
    v_cmp_eq_u32 s[44:45], 0, v249
    v_cmp_eq_u32 s[46:47], 1, v249
    v_cmp_eq_u32 s[48:49], 2, v249
    v_cmp_eq_u32 s[50:51], 3, v249
    v_lshrrev_b32 v248, 1, v247
    v_lshl_add_u32 v236, v248, 4, v236
    v_and_b32 v248, 1, v247
    v_lshl_add_u32 v236, v248, 9, v236
    s_mul_i32 s79, s72, 4224
    s_lshl_b32 s76, s78, 11
    s_add_u32 s79, s79, s76
    s_mul_i32 s61, s72, 3277
    s_lshr_b32 s61, s61, 16
    s_mul_i32 s61, s61, 48
    s_lshl2_add_u32 s61, s72, s61
    s_add_u32 s61, s61, 158720
    s_lshl1_add_u32 s61, s76, s61
    s_lshl_b32 s76, s3, 12
    s_add_u32 s76, s76, 147456
    v_add_u32 v239, s76, v243
    v_xor_b32 v240, 8192, v239
    s_lshl2_add_u32 s76, s3, 42496
    v_mov_b32 v241, s76
    v_xor_b32 v242, 8, v241
    s_mul_i32 s76, s3, 5120
    s_add_u32 s76, s76, 43008
    v_add_u32 v234, s76, v243
    v_lshlrev_b32 v237, 2, v245
    v_add_u32 v237, 42512, v237
    v_lshlrev_b32 v238, 2, v0
    s_lshl_b32 s76, s78, 1
    s_lshl_b32 s76, 128, s76
    s_sub_u32 s76, s76, 1
    s_sub_u32 s77, 5, s78
    v_add_u32 v254, s77, v246
    v_lshlrev_b32_e64 v254, v254, s76
    v_lshlrev_b32 v255, 3, v247
    v_lshrrev_b32 v254, v255, v254
    v_bfe_u32 v250, v254, 0, 1
    v_bfe_u32 v255, v254, 1, 1
    v_lshl_or_b32 v250, v255, 16, v250
    v_mul_u32_u24 v250, 0x3f80, v250
    v_bfe_u32 v251, v254, 2, 1
    v_bfe_u32 v255, v254, 3, 1
    v_lshl_or_b32 v251, v255, 16, v251
    v_mul_u32_u24 v251, 0x3f80, v251
    v_bfe_u32 v252, v254, 4, 1
    v_bfe_u32 v255, v254, 5, 1
    v_lshl_or_b32 v252, v255, 16, v252
    v_mul_u32_u24 v252, 0x3f80, v252
    v_bfe_u32 v253, v254, 6, 1
    v_bfe_u32 v255, v254, 7, 1
    v_lshl_or_b32 v253, v255, 16, v253
    v_mul_u32_u24 v253, 0x3f80, v253
L_kgen:
    v_lshl_add_u32 v3, v0, 4, s74
    v_and_b32 v20, 15, v0
    v_lshrrev_b32 v21, 4, v0
    v_lshrrev_b32 v22, 2, v20
    v_lshl_add_u32 v22, v21, 3, v22
    v_and_b32 v23, 1, v0
    v_lshlrev_b32 v23, 3, v23
    v_lshl_add_u32 v22, v22, 4, v23
    v_add_u32 v17, s74, v22
    v_bfe_u32 v23, v0, 1, 1
    v_mul_u32_u24 v23, 2112, v23
    v_add_u32 v4, v17, v23
    v_lshlrev_b32 v5, 4, v20
    v_lshl_add_u32 v5, v21, 3, v5
    v_mov_b32 v7, 256
    v_mov_b32 v23, 4
    v_lshlrev_b32 v24, 3, v20
    v_add_u32 v24, 512, v24
    v_cmp_eq_u32 vcc, 2, v21
    v_mov_b32 v25, 128
    v_mov_b32 v26, 64
    v_cndmask_b32 v5, v5, v24, vcc
    v_cndmask_b32 v7, v7, v25, vcc
    v_cmp_eq_u32 vcc, 3, v21
    v_lshlrev_b32 v24, 2, v20
    v_add_u32 v24, 768, v24
    v_cndmask_b32 v5, v5, v24, vcc
    v_cndmask_b32 v7, v7, v26, vcc
    v_cndmask_b32 v23, v23, v25, vcc
    v_mul_u32_u24 v24, s57, v7
    v_add3_u32 v5, v5, v24, s75
    v_add_u32 v6, v5, v23
    v_lshlrev_b32 v8, 6, v20
    v_lshl_add_u32 v8, v21, 3, v8
    s_lshl_b32 s8, s57, 5
    s_add_u32 s8, s8, s75
    v_add_u32 v8, s8, v8
    v_mov_b32 v192, 0
    v_mov_b32 v193, 0
    v_mov_b32 v194, 0
    v_mov_b32 v195, 0
    v_mov_b32 v196, 0
    v_mov_b32 v197, 0
    v_mov_b32 v198, 0
    v_mov_b32 v199, 0
    v_mov_b32 v200, 0
    v_mov_b32 v201, 0
    v_mov_b32 v202, 0
    v_mov_b32 v203, 0
    v_mov_b32 v204, 0
    v_mov_b32 v205, 0
    v_mov_b32 v206, 0
    v_mov_b32 v207, 0
    s_mov_b32 s59, 0x3fb8aa3b
    s_cmp_eq_u32 s83, 1
    s_cbranch_scc1 L_kgpass
    s_waitcnt vmcnt(5)
L_kgpass:
    v_mul_f32 v20, s59, v14
    v_mul_f32 v22, s59, v10
    v_exp_f32 v20, v20
    v_exp_f32 v22, v22
    s_nop 0
    v_cvt_pk_bf16_f32 v20, v20, v22
    v_and_b32 v22, 0xffff0000, v20
    v_lshlrev_b32 v20, 16, v20
    v_mul_f32 v22, v22, v20
    v_mul_f32 v23, v11, v20
    v_add_f32 v21, v20, v20
    v_mul_f32 v22, 0xbfb8aa3b, v22
    v_mul_f32 v23, 0.15915494, v23
    v_mul_f32 v126, v12, v21
    v_mul_f32_e64 v127, -v13, v21
    v_mul_f32 v24, 0x41000000, v22
    v_mul_f32 v25, 0x41000000, v23
    v_mul_f32 v26, 0x43800000, v22
    v_mul_f32 v27, 0x43800000, v23
    v_fract_f32 v25, v25
    v_fract_f32 v27, v27
    v_fract_f32 v23, v23
    v_exp_f32 v24, v24
    v_exp_f32 v26, v26
    v_exp_f32 v22, v22
    v_cos_f32 v64, v25
    v_sin_f32 v65, v25
    v_cos_f32 v32, v27
    v_sin_f32 v33, v27
    v_cos_f32 v28, v23
    v_sin_f32 v29, v23
    s_nop 0
    v_pk_mul_f32 v[64:65], v[64:65], v[24:25] op_sel_hi:[1,0]
    v_pk_mul_f32 v[32:33], v[32:33], v[26:27] op_sel_hi:[1,0]
    v_pk_mul_f32 v[28:29], v[28:29], v[22:23] op_sel_hi:[1,0]
    v_pk_mul_f32 v[142:143], v[126:127], v[32:33] op_sel:[0,0] op_sel_hi:[0,1] neg_hi:[1,0]
    v_pk_mul_f32 v[128:129], v[126:127], v[28:29] op_sel:[0,0] op_sel_hi:[0,1] neg_hi:[1,0]
    v_pk_mul_f32 v[66:67], v[64:65], v[64:65] op_sel:[0,0] op_sel_hi:[0,1]
    v_cvt_pk_bf16_f32 v36, 1.0, v64
    v_cvt_pk_bf16_f32 v40, 0, v65
    v_pk_fma_f32 v[142:143], v[126:127], v[32:33], v[142:143] op_sel:[1,1,0] op_sel_hi:[1,0,1]
    v_pk_fma_f32 v[128:129], v[126:127], v[28:29], v[128:129] op_sel:[1,1,0] op_sel_hi:[1,0,1]
    v_pk_fma_f32 v[66:67], v[64:65], v[64:65], v[66:67] op_sel:[1,1,0] op_sel_hi:[1,0,1] neg_lo:[1,0,0]
    v_pk_mul_f32 v[150:151], v[142:143], v[32:33] op_sel:[0,0] op_sel_hi:[0,1] neg_hi:[1,0]
    v_pk_mul_f32 v[130:131], v[128:129], v[28:29] op_sel:[0,0] op_sel_hi:[0,1] neg_hi:[1,0]
    v_pk_mul_f32 v[68:69], v[66:67], v[64:65] op_sel:[0,0] op_sel_hi:[0,1]
    v_pk_mul_f32 v[70:71], v[66:67], v[66:67] op_sel:[0,0] op_sel_hi:[0,1]
    v_cvt_pk_bf16_f32 v176, v126, v128
    v_cvt_pk_bf16_f32 v180, v127, v129
    v_pk_fma_f32 v[150:151], v[142:143], v[32:33], v[150:151] op_sel:[1,1,0] op_sel_hi:[1,0,1]
    v_pk_fma_f32 v[130:131], v[128:129], v[28:29], v[130:131] op_sel:[1,1,0] op_sel_hi:[1,0,1]
    v_pk_fma_f32 v[68:69], v[66:67], v[64:65], v[68:69] op_sel:[1,1,0] op_sel_hi:[1,0,1] neg_lo:[1,0,0]
    v_pk_fma_f32 v[70:71], v[66:67], v[66:67], v[70:71] op_sel:[1,1,0] op_sel_hi:[1,0,1] neg_lo:[1,0,0]
    v_pk_mul_f32 v[154:155], v[150:151], v[32:33] op_sel:[0,0] op_sel_hi:[0,1] neg_hi:[1,0]
    v_pk_mul_f32 v[132:133], v[130:131], v[28:29] op_sel:[0,0] op_sel_hi:[0,1] neg_hi:[1,0]
    v_pk_mul_f32 v[72:73], v[70:71], v[64:65] op_sel:[0,0] op_sel_hi:[0,1]
    v_pk_mul_f32 v[74:75], v[70:71], v[66:67] op_sel:[0,0] op_sel_hi:[0,1]
    v_cvt_pk_bf16_f32 v37, v66, v68
    v_cvt_pk_bf16_f32 v41, v67, v69
    v_pk_fma_f32 v[154:155], v[150:151], v[32:33], v[154:155] op_sel:[1,1,0] op_sel_hi:[1,0,1]
    v_pk_fma_f32 v[132:133], v[130:131], v[28:29], v[132:133] op_sel:[1,1,0] op_sel_hi:[1,0,1]
    v_pk_fma_f32 v[72:73], v[70:71], v[64:65], v[72:73] op_sel:[1,1,0] op_sel_hi:[1,0,1] neg_lo:[1,0,0]
    v_pk_fma_f32 v[74:75], v[70:71], v[66:67], v[74:75] op_sel:[1,1,0] op_sel_hi:[1,0,1] neg_lo:[1,0,0]
    v_pk_mul_f32 v[158:159], v[154:155], v[32:33] op_sel:[0,0] op_sel_hi:[0,1] neg_hi:[1,0]
    v_pk_mul_f32 v[134:135], v[132:133], v[28:29] op_sel:[0,0] op_sel_hi:[0,1] neg_hi:[1,0]
    v_pk_mul_f32 v[76:77], v[70:71], v[68:69] op_sel:[0,0] op_sel_hi:[0,1]
    v_pk_mul_f32 v[78:79], v[70:71], v[70:71] op_sel:[0,0] op_sel_hi:[0,1]
    v_cvt_pk_bf16_f32 v38, v70, v72
    v_cvt_pk_bf16_f32 v42, v71, v73
    v_cvt_pk_bf16_f32 v177, v130, v132
    v_cvt_pk_bf16_f32 v181, v131, v133
    v_pk_fma_f32 v[158:159], v[154:155], v[32:33], v[158:159] op_sel:[1,1,0] op_sel_hi:[1,0,1]
    v_pk_fma_f32 v[134:135], v[132:133], v[28:29], v[134:135] op_sel:[1,1,0] op_sel_hi:[1,0,1]
    v_pk_fma_f32 v[76:77], v[70:71], v[68:69], v[76:77] op_sel:[1,1,0] op_sel_hi:[1,0,1] neg_lo:[1,0,0]
    v_pk_fma_f32 v[78:79], v[70:71], v[70:71], v[78:79] op_sel:[1,1,0] op_sel_hi:[1,0,1] neg_lo:[1,0,0]
    v_pk_mul_f32 v[160:161], v[158:159], v[32:33] op_sel:[0,0] op_sel_hi:[0,1] neg_hi:[1,0]
    v_pk_mul_f32 v[136:137], v[134:135], v[28:29] op_sel:[0,0] op_sel_hi:[0,1] neg_hi:[1,0]
    v_pk_mul_f32 v[146:147], v[134:135], v[32:33] op_sel:[0,0] op_sel_hi:[0,1] neg_hi:[1,0]
    v_pk_mul_f32 v[80:81], v[78:79], v[64:65] op_sel:[0,0] op_sel_hi:[0,1]
    v_cvt_pk_bf16_f32 v39, v74, v76
    v_cvt_pk_bf16_f32 v43, v75, v77
    v_pk_fma_f32 v[160:161], v[158:159], v[32:33], v[160:161] op_sel:[1,1,0] op_sel_hi:[1,0,1]
    v_pk_fma_f32 v[136:137], v[134:135], v[28:29], v[136:137] op_sel:[1,1,0] op_sel_hi:[1,0,1]
    v_pk_fma_f32 v[146:147], v[134:135], v[32:33], v[146:147] op_sel:[1,1,0] op_sel_hi:[1,0,1]
    v_pk_fma_f32 v[80:81], v[78:79], v[64:65], v[80:81] op_sel:[1,1,0] op_sel_hi:[1,0,1] neg_lo:[1,0,0]
    v_pk_mul_f32 v[162:163], v[160:161], v[32:33] op_sel:[0,0] op_sel_hi:[0,1] neg_hi:[1,0]
    v_pk_mul_f32 v[138:139], v[136:137], v[28:29] op_sel:[0,0] op_sel_hi:[0,1] neg_hi:[1,0]
    v_pk_mul_f32 v[152:153], v[146:147], v[32:33] op_sel:[0,0] op_sel_hi:[0,1] neg_hi:[1,0]
    v_pk_mul_f32 v[144:145], v[130:131], v[32:33] op_sel:[0,0] op_sel_hi:[0,1] neg_hi:[1,0]
    v_cvt_pk_bf16_f32 v44, v78, v80
    v_cvt_pk_bf16_f32 v48, v79, v81
    v_cvt_pk_bf16_f32 v178, v134, v136
    v_cvt_pk_bf16_f32 v182, v135, v137
    v_cvt_pk_bf16_f32 v52, v158, v160
    v_cvt_pk_bf16_f32 v56, v159, v161
    v_pk_fma_f32 v[162:163], v[160:161], v[32:33], v[162:163] op_sel:[1,1,0] op_sel_hi:[1,0,1]
    v_pk_fma_f32 v[138:139], v[136:137], v[28:29], v[138:139] op_sel:[1,1,0] op_sel_hi:[1,0,1]
    v_pk_fma_f32 v[152:153], v[146:147], v[32:33], v[152:153] op_sel:[1,1,0] op_sel_hi:[1,0,1]
    v_pk_fma_f32 v[144:145], v[130:131], v[32:33], v[144:145] op_sel:[1,1,0] op_sel_hi:[1,0,1]
    v_pk_mul_f32 v[164:165], v[162:163], v[32:33] op_sel:[0,0] op_sel_hi:[0,1] neg_hi:[1,0]
    v_pk_mul_f32 v[140:141], v[138:139], v[28:29] op_sel:[0,0] op_sel_hi:[0,1] neg_hi:[1,0]
    v_pk_mul_f32 v[82:83], v[78:79], v[66:67] op_sel:[0,0] op_sel_hi:[0,1]
    v_pk_mul_f32 v[84:85], v[78:79], v[68:69] op_sel:[0,0] op_sel_hi:[0,1]
    v_cvt_pk_bf16_f32 v184, v142, v144
    v_cvt_pk_bf16_f32 v188, v143, v145
    v_cvt_pk_bf16_f32 v186, v150, v152
    v_cvt_pk_bf16_f32 v190, v151, v153
    v_pk_fma_f32 v[164:165], v[162:163], v[32:33], v[164:165] op_sel:[1,1,0] op_sel_hi:[1,0,1]
    v_pk_fma_f32 v[140:141], v[138:139], v[28:29], v[140:141] op_sel:[1,1,0] op_sel_hi:[1,0,1]
    v_pk_fma_f32 v[82:83], v[78:79], v[66:67], v[82:83] op_sel:[1,1,0] op_sel_hi:[1,0,1] neg_lo:[1,0,0]
    v_pk_fma_f32 v[84:85], v[78:79], v[68:69], v[84:85] op_sel:[1,1,0] op_sel_hi:[1,0,1] neg_lo:[1,0,0]
    v_pk_mul_f32 v[148:149], v[138:139], v[32:33] op_sel:[0,0] op_sel_hi:[0,1] neg_hi:[1,0]
    v_pk_mul_f32 v[86:87], v[78:79], v[70:71] op_sel:[0,0] op_sel_hi:[0,1]
    v_pk_mul_f32 v[88:89], v[78:79], v[72:73] op_sel:[0,0] op_sel_hi:[0,1]
    v_pk_mul_f32 v[90:91], v[78:79], v[74:75] op_sel:[0,0] op_sel_hi:[0,1]
    v_cvt_pk_bf16_f32 v45, v82, v84
    v_cvt_pk_bf16_f32 v49, v83, v85
    v_cvt_pk_bf16_f32 v179, v138, v140
    v_cvt_pk_bf16_f32 v183, v139, v141
    v_cvt_pk_bf16_f32 v53, v162, v164
    v_cvt_pk_bf16_f32 v57, v163, v165
    v_pk_fma_f32 v[148:149], v[138:139], v[32:33], v[148:149] op_sel:[1,1,0] op_sel_hi:[1,0,1]
    v_pk_fma_f32 v[86:87], v[78:79], v[70:71], v[86:87] op_sel:[1,1,0] op_sel_hi:[1,0,1] neg_lo:[1,0,0]
    v_pk_fma_f32 v[88:89], v[78:79], v[72:73], v[88:89] op_sel:[1,1,0] op_sel_hi:[1,0,1] neg_lo:[1,0,0]
    v_pk_fma_f32 v[90:91], v[78:79], v[74:75], v[90:91] op_sel:[1,1,0] op_sel_hi:[1,0,1] neg_lo:[1,0,0]
    v_pk_mul_f32 v[92:93], v[78:79], v[76:77] op_sel:[0,0] op_sel_hi:[0,1]
    v_pk_mul_f32 v[156:157], v[152:153], v[32:33] op_sel:[0,0] op_sel_hi:[0,1] neg_hi:[1,0]
    v_pk_mul_f32 v[166:167], v[164:165], v[32:33] op_sel:[0,0] op_sel_hi:[0,1] neg_hi:[1,0]
    v_cvt_pk_bf16_f32 v46, v86, v88
    v_cvt_pk_bf16_f32 v50, v87, v89
    v_cvt_pk_bf16_f32 v185, v146, v148
    v_cvt_pk_bf16_f32 v189, v147, v149
    v_pk_fma_f32 v[92:93], v[78:79], v[76:77], v[92:93] op_sel:[1,1,0] op_sel_hi:[1,0,1] neg_lo:[1,0,0]
    v_pk_fma_f32 v[156:157], v[152:153], v[32:33], v[156:157] op_sel:[1,1,0] op_sel_hi:[1,0,1]
    v_pk_fma_f32 v[166:167], v[164:165], v[32:33], v[166:167] op_sel:[1,1,0] op_sel_hi:[1,0,1]
    v_cvt_pk_bf16_f32 v47, v90, v92
    v_cvt_pk_bf16_f32 v51, v91, v93
    v_cvt_pk_bf16_f32 v187, v154, v156
    v_cvt_pk_bf16_f32 v191, v155, v157
    v_cvt_pk_bf16_f32 v54, v166, v166
    v_cvt_pk_bf16_f32 v58, v167, v167
    ds_write_b128 v3, v[36:39] offset:0
    ds_write_b128 v3, v[40:43] offset:1024
    ds_write_b128 v3, v[44:47] offset:2112
    ds_write_b128 v3, v[48:51] offset:3136
    ds_read_b64_tr_b16 v[160:161], v4 offset:0
    ds_read_b64_tr_b16 v[162:163], v4 offset:64
    ds_read_b64_tr_b16 v[164:165], v4 offset:512
    ds_read_b64_tr_b16 v[166:167], v4 offset:576
    ds_read_b64_tr_b16 v[168:169], v4 offset:1024
    ds_read_b64_tr_b16 v[170:171], v4 offset:1088
    ds_read_b64_tr_b16 v[172:173], v4 offset:1536
    ds_read_b64_tr_b16 v[174:175], v4 offset:1600
    ds_write_b128 v3, v[176:179] offset:0
    ds_write_b128 v3, v[180:183] offset:1024
    ds_write_b128 v3, v[184:187] offset:2112
    ds_write_b128 v3, v[188:191] offset:3136
    ds_read_b64_tr_b16 v[128:129], v4 offset:0
    ds_read_b64_tr_b16 v[130:131], v4 offset:64
    ds_read_b64_tr_b16 v[132:133], v4 offset:512
    ds_read_b64_tr_b16 v[134:135], v4 offset:576
    ds_read_b64_tr_b16 v[136:137], v4 offset:1024
    ds_read_b64_tr_b16 v[138:139], v4 offset:1088
    ds_read_b64_tr_b16 v[140:141], v4 offset:1536
    ds_read_b64_tr_b16 v[142:143], v4 offset:1600
    ds_write_b128 v3, v[52:55] offset:0
    ds_write_b128 v3, v[56:59] offset:1024
    ds_read_b64_tr_b16 v[144:145], v17 offset:0
    ds_read_b64_tr_b16 v[146:147], v17 offset:64
    ds_read_b64_tr_b16 v[148:149], v17 offset:512
    ds_read_b64_tr_b16 v[150:151], v17 offset:576
    ds_read_b64_tr_b16 v[152:153], v17 offset:1024
    ds_read_b64_tr_b16 v[154:155], v17 offset:1088
    ds_read_b64_tr_b16 v[156:157], v17 offset:1536
    ds_read_b64_tr_b16 v[158:159], v17 offset:1600
    v_pk_mul_f32 v[94:95], v[78:79], v[78:79] op_sel:[0,0] op_sel_hi:[0,1]
    v_pk_mul_f32 v[96:97], v[80:81], v[78:79] op_sel:[0,0] op_sel_hi:[0,1]
    v_pk_mul_f32 v[98:99], v[82:83], v[78:79] op_sel:[0,0] op_sel_hi:[0,1]
    v_pk_mul_f32 v[100:101], v[84:85], v[78:79] op_sel:[0,0] op_sel_hi:[0,1]
    v_pk_fma_f32 v[94:95], v[78:79], v[78:79], v[94:95] op_sel:[1,1,0] op_sel_hi:[1,0,1] neg_lo:[1,0,0]
    v_pk_fma_f32 v[96:97], v[80:81], v[78:79], v[96:97] op_sel:[1,1,0] op_sel_hi:[1,0,1] neg_lo:[1,0,0]
    v_pk_fma_f32 v[98:99], v[82:83], v[78:79], v[98:99] op_sel:[1,1,0] op_sel_hi:[1,0,1] neg_lo:[1,0,0]
    v_pk_fma_f32 v[100:101], v[84:85], v[78:79], v[100:101] op_sel:[1,1,0] op_sel_hi:[1,0,1] neg_lo:[1,0,0]
    v_pk_mul_f32 v[102:103], v[94:95], v[70:71] op_sel:[0,0] op_sel_hi:[0,1]
    v_pk_mul_f32 v[104:105], v[94:95], v[72:73] op_sel:[0,0] op_sel_hi:[0,1]
    v_pk_mul_f32 v[106:107], v[94:95], v[74:75] op_sel:[0,0] op_sel_hi:[0,1]
    v_pk_mul_f32 v[108:109], v[94:95], v[76:77] op_sel:[0,0] op_sel_hi:[0,1]
    v_cvt_pk_bf16_f32 v36, v94, v96
    v_cvt_pk_bf16_f32 v40, v95, v97
    v_cvt_pk_bf16_f32 v37, v98, v100
    v_cvt_pk_bf16_f32 v41, v99, v101
    v_pk_fma_f32 v[102:103], v[94:95], v[70:71], v[102:103] op_sel:[1,1,0] op_sel_hi:[1,0,1] neg_lo:[1,0,0]
    v_pk_fma_f32 v[104:105], v[94:95], v[72:73], v[104:105] op_sel:[1,1,0] op_sel_hi:[1,0,1] neg_lo:[1,0,0]
    v_pk_fma_f32 v[106:107], v[94:95], v[74:75], v[106:107] op_sel:[1,1,0] op_sel_hi:[1,0,1] neg_lo:[1,0,0]
    v_pk_fma_f32 v[108:109], v[94:95], v[76:77], v[108:109] op_sel:[1,1,0] op_sel_hi:[1,0,1] neg_lo:[1,0,0]
    v_pk_mul_f32 v[110:111], v[94:95], v[78:79] op_sel:[0,0] op_sel_hi:[0,1]
    v_pk_mul_f32 v[112:113], v[94:95], v[80:81] op_sel:[0,0] op_sel_hi:[0,1]
    v_pk_mul_f32 v[114:115], v[94:95], v[82:83] op_sel:[0,0] op_sel_hi:[0,1]
    v_pk_mul_f32 v[116:117], v[94:95], v[84:85] op_sel:[0,0] op_sel_hi:[0,1]
    v_cvt_pk_bf16_f32 v38, v102, v104
    v_cvt_pk_bf16_f32 v42, v103, v105
    v_cvt_pk_bf16_f32 v39, v106, v108
    v_cvt_pk_bf16_f32 v43, v107, v109
    v_pk_fma_f32 v[110:111], v[94:95], v[78:79], v[110:111] op_sel:[1,1,0] op_sel_hi:[1,0,1] neg_lo:[1,0,0]
    v_pk_fma_f32 v[112:113], v[94:95], v[80:81], v[112:113] op_sel:[1,1,0] op_sel_hi:[1,0,1] neg_lo:[1,0,0]
    v_pk_fma_f32 v[114:115], v[94:95], v[82:83], v[114:115] op_sel:[1,1,0] op_sel_hi:[1,0,1] neg_lo:[1,0,0]
    v_pk_fma_f32 v[116:117], v[94:95], v[84:85], v[116:117] op_sel:[1,1,0] op_sel_hi:[1,0,1] neg_lo:[1,0,0]
    v_pk_mul_f32 v[118:119], v[94:95], v[86:87] op_sel:[0,0] op_sel_hi:[0,1]
    v_pk_mul_f32 v[120:121], v[94:95], v[88:89] op_sel:[0,0] op_sel_hi:[0,1]
    v_pk_mul_f32 v[122:123], v[94:95], v[90:91] op_sel:[0,0] op_sel_hi:[0,1]
    v_pk_mul_f32 v[124:125], v[94:95], v[92:93] op_sel:[0,0] op_sel_hi:[0,1]
    v_cvt_pk_bf16_f32 v44, v110, v112
    v_cvt_pk_bf16_f32 v48, v111, v113
    v_cvt_pk_bf16_f32 v45, v114, v116
    v_cvt_pk_bf16_f32 v49, v115, v117
    v_pk_fma_f32 v[118:119], v[94:95], v[86:87], v[118:119] op_sel:[1,1,0] op_sel_hi:[1,0,1] neg_lo:[1,0,0]
    v_pk_fma_f32 v[120:121], v[94:95], v[88:89], v[120:121] op_sel:[1,1,0] op_sel_hi:[1,0,1] neg_lo:[1,0,0]
    v_pk_fma_f32 v[122:123], v[94:95], v[90:91], v[122:123] op_sel:[1,1,0] op_sel_hi:[1,0,1] neg_lo:[1,0,0]
    v_pk_fma_f32 v[124:125], v[94:95], v[92:93], v[124:125] op_sel:[1,1,0] op_sel_hi:[1,0,1] neg_lo:[1,0,0]
    v_cvt_pk_bf16_f32 v46, v118, v120
    v_cvt_pk_bf16_f32 v50, v119, v121
    v_cvt_pk_bf16_f32 v47, v122, v124
    v_cvt_pk_bf16_f32 v51, v123, v125
    ds_write_b128 v3, v[36:39] offset:0
    ds_write_b128 v3, v[40:43] offset:1024
    ds_write_b128 v3, v[44:47] offset:2112
    ds_write_b128 v3, v[48:51] offset:3136
    ds_read_b64_tr_b16 v[176:177], v4 offset:0
    ds_read_b64_tr_b16 v[178:179], v4 offset:64
    ds_read_b64_tr_b16 v[180:181], v4 offset:512
    ds_read_b64_tr_b16 v[182:183], v4 offset:576
    ds_read_b64_tr_b16 v[184:185], v4 offset:1024
    ds_read_b64_tr_b16 v[186:187], v4 offset:1088
    ds_read_b64_tr_b16 v[188:189], v4 offset:1536
    ds_read_b64_tr_b16 v[190:191], v4 offset:1600
    s_waitcnt lgkmcnt(12)
    v_mfma_f32_16x16x32_bf16 v[192:195], v[128:131], v[160:163], v[192:195]
    v_mfma_f32_16x16x32_bf16 v[196:199], v[160:163], v[144:147], v[196:199]
    v_mfma_f32_16x16x32_bf16 v[192:195], v[132:135], v[164:167], v[192:195]
    v_mfma_f32_16x16x32_bf16 v[196:199], v[164:167], v[148:151], v[196:199]
    v_mfma_f32_16x16x32_bf16 v[192:195], v[136:139], v[168:171], v[192:195]
    v_mfma_f32_16x16x32_bf16 v[196:199], v[168:171], v[152:155], v[196:199]
    v_mfma_f32_16x16x32_bf16 v[192:195], v[140:143], v[172:175], v[192:195]
    v_mfma_f32_16x16x32_bf16 v[196:199], v[172:175], v[156:159], v[196:199]
    s_waitcnt lgkmcnt(6)
    v_mfma_f32_16x16x32_bf16 v[200:203], v[128:131], v[176:179], v[200:203]
    v_mfma_f32_16x16x32_bf16 v[204:207], v[176:179], v[144:147], v[204:207]
    s_waitcnt lgkmcnt(4)
    v_mfma_f32_16x16x32_bf16 v[200:203], v[132:135], v[180:183], v[200:203]
    v_mfma_f32_16x16x32_bf16 v[204:207], v[180:183], v[148:151], v[204:207]
    s_waitcnt lgkmcnt(2)
    v_mfma_f32_16x16x32_bf16 v[200:203], v[136:139], v[184:187], v[200:203]
    v_mfma_f32_16x16x32_bf16 v[204:207], v[184:187], v[152:155], v[204:207]
    s_waitcnt lgkmcnt(0)
    v_mfma_f32_16x16x32_bf16 v[200:203], v[140:143], v[188:191], v[200:203]
    v_mfma_f32_16x16x32_bf16 v[204:207], v[188:191], v[156:159], v[204:207]
    s_cmp_eq_u32 s83, 1
    s_cbranch_scc1 L_aux_kpass
L_nokg:
    s_xor_b32 s8, s3, 2
    s_mul_i32 s8, s8, 4352
    s_add_u32 s8, s8, 80896
    v_lshl_add_u32 v9, v0, 4, s8
L_ln2:
    s_mov_b32 s10, 0x3f803f80
    s_mov_b32 s11, 0x3f80
    s_mov_b32 s12, 0x3f800000
    s_waitcnt vmcnt(0)
    v_dot2_f32_bf16 v36, v208, s10, 0
    v_dot2_f32_bf16 v37, v209, s10, 0
    v_dot2_f32_bf16 v36, v210, s10, v36
    v_dot2_f32_bf16 v37, v211, s10, v37
    v_dot2_f32_bf16 v36, v212, s10, v36
    v_dot2_f32_bf16 v37, v213, s10, v37
    v_dot2_f32_bf16 v36, v214, s10, v36
    v_dot2_f32_bf16 v37, v215, s10, v37
    v_dot2_f32_bf16 v36, v216, s10, v36
    v_dot2_f32_bf16 v37, v217, s10, v37
    s_mul_i32 s13, s3, 2624
    s_add_u32 s13, s13, 147456
    v_mul_u32_u24 v222, 1312, v220
    v_add_f32 v32, v36, v37
    s_lshr_b32 s4, s3, 1
    s_and_b32 s5, s3, 1
    v_add_f32_dpp v32, v32, v32 quad_perm:[1,0,3,2] row_mask:0xf bank_mask:0xf
    v_and_b32 v230, 15, v0
    v_lshrrev_b32 v231, 4, v0
    v_add_f32_dpp v32, v32, v32 quad_perm:[2,3,0,1] row_mask:0xf bank_mask:0xf
    v_lshrrev_b32 v224, 1, v230
    s_lshl_b32 s6, s4, 14
    v_add_f32_dpp v32, v32, v32 row_half_mirror row_mask:0xf bank_mask:0xf
    s_add_u32 s6, s6, 114688
    v_add_u32 v225, 0, v231
    v_add_f32_dpp v32, v32, v32 row_mirror row_mask:0xf bank_mask:0xf
    v_mov_b32 v38, v32
    v_xor_b32 v225, v225, v224
    v_lshlrev_b32 v225, 4, v225
    v_permlane16_swap_b32 v32, v38
    v_add_f32 v32, v32, v38
    v_lshl_add_u32 v10, v230, 7, v225
    v_add_u32 v10, s6, v10
    v_add_u32 v225, 4, v231
    v_xor_b32 v225, v225, v224
    v_lshlrev_b32 v225, 4, v225
    v_lshl_add_u32 v11, v230, 7, v225
    v_mul_f32 v32, 0x3acccccd, v32
    v_cvt_pk_bf16_f32 v34, v32, v32
    v_lshlrev_b32 v34, 16, v34
    v_sub_f32 v33, v32, v34
    v_xor_b32 v31, 0x80000000, v34
    v_dot2_f32_bf16 v64, v208, s11, v31
    v_dot2_f32_bf16 v65, v208, s12, v31
    v_dot2_f32_bf16 v66, v209, s11, v31
    v_dot2_f32_bf16 v67, v209, s12, v31
    v_dot2_f32_bf16 v68, v210, s11, v31
    v_dot2_f32_bf16 v69, v210, s12, v31
    v_dot2_f32_bf16 v70, v211, s11, v31
    v_dot2_f32_bf16 v71, v211, s12, v31
    v_dot2_f32_bf16 v72, v212, s11, v31
    v_dot2_f32_bf16 v73, v212, s12, v31
    v_dot2_f32_bf16 v74, v213, s11, v31
    v_dot2_f32_bf16 v75, v213, s12, v31
    v_dot2_f32_bf16 v76, v214, s11, v31
    v_dot2_f32_bf16 v77, v214, s12, v31
    v_dot2_f32_bf16 v78, v215, s11, v31
    v_dot2_f32_bf16 v79, v215, s12, v31
    v_dot2_f32_bf16 v80, v216, s11, v31
    v_dot2_f32_bf16 v81, v216, s12, v31
    v_dot2_f32_bf16 v82, v217, s11, v31
    v_dot2_f32_bf16 v83, v217, s12, v31
    v_lshl_add_u32 v222, v221, 3, v222
    v_add_u32 v222, s13, v222
    v_pk_mul_f32 v[36:37], v[64:65], v[64:65]
    v_pk_mul_f32 v[38:39], v[66:67], v[66:67]
    v_pk_fma_f32 v[36:37], v[68:69], v[68:69], v[36:37]
    v_pk_fma_f32 v[38:39], v[70:71], v[70:71], v[38:39]
    v_pk_fma_f32 v[36:37], v[72:73], v[72:73], v[36:37]
    v_pk_fma_f32 v[38:39], v[74:75], v[74:75], v[38:39]
    v_pk_fma_f32 v[36:37], v[76:77], v[76:77], v[36:37]
    v_pk_fma_f32 v[38:39], v[78:79], v[78:79], v[38:39]
    v_pk_fma_f32 v[36:37], v[80:81], v[80:81], v[36:37]
    v_pk_fma_f32 v[38:39], v[82:83], v[82:83], v[38:39]
    v_pk_add_f32 v[36:37], v[36:37], v[38:39]
    s_lshl_b32 s13, s3, 5
    s_add_u32 s13, s13, 157952
    v_add_f32 v32, v36, v37
    v_add_u32 v11, s6, v11
    v_lshrrev_b32 v226, 2, v230
    v_add_f32_dpp v32, v32, v32 quad_perm:[1,0,3,2] row_mask:0xf bank_mask:0xf
    v_and_b32 v225, 3, v230
    v_lshlrev_b32 v225, 3, v225
    v_add_f32_dpp v32, v32, v32 quad_perm:[2,3,0,1] row_mask:0xf bank_mask:0xf
    v_lshrrev_b32 v228, 1, v226
    v_and_b32 v227, 1, v231
    v_add_f32_dpp v32, v32, v32 row_half_mirror row_mask:0xf bank_mask:0xf
    v_lshl_add_u32 v228, v227, 1, v228
    v_lshl_add_u32 v226, v231, 3, v226
    v_add_f32_dpp v32, v32, v32 row_mirror row_mask:0xf bank_mask:0xf
    v_mov_b32 v38, v32
    v_add_u32 v225, 98304, v225
    s_lshl_b32 s6, s5, 1
    v_permlane16_swap_b32 v32, v38
    v_add_f32 v32, v32, v38
    v_xor_b32 v228, s6, v228
    v_xor_b32 v229, 0, v228
    v_lshl_add_u32 v229, v229, 5, v225
    v_lshl_add_u32 v12, v226, 7, v229
    v_xor_b32 v229, 1, v228
    v_lshl_add_u32 v229, v229, 5, v225
    v_lshl_add_u32 v13, v226, 7, v229
    v_lshl_add_u32 v223, v220, 4, s13
    v_mul_f32 v32, 0x3acccccd, v32
    v_fma_f32 v32, -v33, v33, v32
    v_max_f32 v32, 0, v32
    v_cvt_pk_bf16_f32 v32, v32, v32
    v_lshlrev_b32 v32, 16, v32
    v_add_f32 v32, 0x3727c5ac, v32
    v_cvt_pk_bf16_f32 v32, v32, v32
    v_lshlrev_b32 v32, 16, v32
    v_sqrt_f32 v32, v32
    v_mov_b32 v28, v34
    v_cvt_pk_bf16_f32 v32, v32, v32
    v_lshlrev_b32 v32, 16, v32
    v_rcp_f32 v35, v32
    v_mul_f32 v30, v32, v32
    v_mul_f32 v29, 0xbfb8aa3b, v35
    v_pk_mul_f32 v[64:65], v[64:65], v[34:35] op_sel:[0,1] op_sel_hi:[1,1]
    v_pk_mul_f32 v[66:67], v[66:67], v[34:35] op_sel:[0,1] op_sel_hi:[1,1]
    v_pk_mul_f32 v[68:69], v[68:69], v[34:35] op_sel:[0,1] op_sel_hi:[1,1]
    v_pk_mul_f32 v[70:71], v[70:71], v[34:35] op_sel:[0,1] op_sel_hi:[1,1]
    v_pk_mul_f32 v[72:73], v[72:73], v[34:35] op_sel:[0,1] op_sel_hi:[1,1]
    v_pk_mul_f32 v[74:75], v[74:75], v[34:35] op_sel:[0,1] op_sel_hi:[1,1]
    v_pk_mul_f32 v[76:77], v[76:77], v[34:35] op_sel:[0,1] op_sel_hi:[1,1]
    v_pk_mul_f32 v[78:79], v[78:79], v[34:35] op_sel:[0,1] op_sel_hi:[1,1]
    v_pk_mul_f32 v[80:81], v[80:81], v[34:35] op_sel:[0,1] op_sel_hi:[1,1]
    v_pk_mul_f32 v[82:83], v[82:83], v[34:35] op_sel:[0,1] op_sel_hi:[1,1]
    ds_write_b128 v223, v[28:31]
    v_cvt_pk_bf16_f32 v208, v64, v65
    v_cvt_pk_bf16_f32 v209, v66, v67
    ds_write_b64 v222, v[208:209] offset:0
    v_cvt_pk_bf16_f32 v210, v68, v69
    v_cvt_pk_bf16_f32 v211, v70, v71
    ds_write_b64 v222, v[210:211] offset:256
    v_cvt_pk_bf16_f32 v212, v72, v73
    v_cvt_pk_bf16_f32 v213, v74, v75
    ds_write_b64 v222, v[212:213] offset:512
    v_cvt_pk_bf16_f32 v214, v76, v77
    v_cvt_pk_bf16_f32 v215, v78, v79
    ds_write_b64 v222, v[214:215] offset:768
    v_cvt_pk_bf16_f32 v216, v80, v81
    v_cvt_pk_bf16_f32 v217, v82, v83
    ds_write_b64 v222, v[216:217] offset:1024
    s_cmp_eq_u32 s57, 0
    s_cbranch_scc1 L_kx0
    ds_write_b128 v3, v[192:195]
    ds_write_b128 v3, v[196:199] offset:1024
    v_mov_b32 v192, v200
    v_mov_b32 v193, v201
    v_mov_b32 v194, v202
    v_mov_b32 v195, v203
    v_mov_b32 v196, v204
    v_mov_b32 v197, v205
    v_mov_b32 v198, v206
    v_mov_b32 v199, v207
    s_branch L_kx1
L_kx0:
    ds_write_b128 v3, v[200:203]
    ds_write_b128 v3, v[204:207] offset:1024
L_kx1:
    s_mov_b32 s7, 0
    s_mov_b32 s8, 0
    s_waitcnt lgkmcnt(0)
    s_cmp_eq_u32 s83, 1
    s_cbranch_scc1 L_aux_rowsdone
    s_barrier
    ds_read_b128 v[24:27], v9 offset:0
    ds_read_b128 v[28:31], v9 offset:1024
    ds_read_b64_tr_b16 v[64:65], v12 offset:0
    ds_read_b64_tr_b16 v[66:67], v12 offset:512
    ds_read_b64_tr_b16 v[68:69], v13 offset:0
    ds_read_b64_tr_b16 v[70:71], v13 offset:512
    ds_read_b64_tr_b16 v[72:73], v12 offset:8192
    ds_read_b64_tr_b16 v[74:75], v12 offset:8704
    ds_read_b64_tr_b16 v[76:77], v13 offset:8192
    ds_read_b64_tr_b16 v[78:79], v13 offset:8704
    ds_read_b128 v[32:35], v10 offset:0
    ds_read_b128 v[36:39], v10 offset:2048
    ds_read_b128 v[40:43], v10 offset:4096
    ds_read_b128 v[44:47], v10 offset:6144
    s_waitcnt lgkmcnt(12)
    s_barrier
    ds_read_b128 v[48:51], v10 offset:8192
    ds_read_b128 v[52:55], v10 offset:10240
    ds_read_b128 v[56:59], v10 offset:12288
    ds_read_b128 v[60:63], v10 offset:14336
    v_add_f32 v192, v192, v24
    v_add_f32 v193, v193, v25
    v_add_f32 v194, v194, v26
    v_add_f32 v195, v195, v27
    v_add_f32 v196, v196, v28
    v_add_f32 v197, v197, v29
    v_add_f32 v198, v198, v30
    v_add_f32 v199, v199, v31
    s_waitcnt lgkmcnt(0)
    v_mfma_f32_16x16x32_bf16 v[128:131], v[64:67], v[32:35], 0
    v_cvt_pk_bf16_f32 v20, v192, v193
    ds_read_b64_tr_b16 v[112:113], v12 offset:4096
    v_mfma_f32_16x16x32_bf16 v[132:135], v[68:71], v[32:35], 0
    v_cvt_pk_bf16_f32 v21, v194, v195
    ds_read_b64_tr_b16 v[114:115], v12 offset:4608
    v_mfma_f32_16x16x32_bf16 v[136:139], v[72:75], v[32:35], 0
    v_cvt_pk_bf16_f32 v22, v196, v197
    ds_read_b64_tr_b16 v[116:117], v13 offset:4096
    v_mfma_f32_16x16x32_bf16 v[140:143], v[76:79], v[32:35], 0
    v_cvt_pk_bf16_f32 v23, v198, v199
    ds_read_b64_tr_b16 v[118:119], v13 offset:4608
    v_mfma_f32_16x16x32_bf16 v[156:159], v[76:79], v[36:39], 0
    ds_write_b32 v5, v20
    ds_read_b64_tr_b16 v[120:121], v12 offset:12288
    v_mfma_f32_16x16x32_bf16 v[152:155], v[72:75], v[36:39], 0
    ds_write_b32 v6, v21
    v_mfma_f32_16x16x32_bf16 v[148:151], v[68:71], v[36:39], 0
    ds_read_b64_tr_b16 v[122:123], v12 offset:12800
    s_mov_b32 exec_lo, 0x001f001f
    s_mov_b32 exec_hi, 0x001f001f
    ds_write_b64 v8, v[22:23] offset:1024
    s_mov_b64 exec, -1
    v_mfma_f32_16x16x32_bf16 v[144:147], v[64:67], v[36:39], 0
    ds_read_b64_tr_b16 v[124:125], v13 offset:12288
    v_mov_b32 v6, v230
    v_mfma_f32_16x16x32_bf16 v[160:163], v[64:67], v[40:43], 0
    ds_read_b64_tr_b16 v[126:127], v13 offset:12800
    v_mov_b32 v7, v231
    v_mfma_f32_16x16x32_bf16 v[164:167], v[68:71], v[40:43], 0
    ds_read_b128 v[80:83], v11 offset:0
    v_mov_b32 v1, v232
    v_mfma_f32_16x16x32_bf16 v[168:171], v[72:75], v[40:43], 0
    ds_read_b128 v[84:87], v11 offset:2048
    v_mfma_f32_16x16x32_bf16 v[172:175], v[76:79], v[40:43], 0
    v_mov_b32 v5, v233
    ds_read_b128 v[88:91], v11 offset:4096
    v_mfma_f32_16x16x32_bf16 v[188:191], v[76:79], v[44:47], 0
    v_mov_b32 v14, v234
    ds_read_b128 v[92:95], v11 offset:6144
    v_mfma_f32_16x16x32_bf16 v[184:187], v[72:75], v[44:47], 0
    v_mov_b32 v15, v235
    ds_read_b128 v[96:99], v11 offset:8192
    v_mfma_f32_16x16x32_bf16 v[180:183], v[68:71], v[44:47], 0
    v_mov_b32 v16, v236
    ds_read_b128 v[100:103], v11 offset:10240
    v_mfma_f32_16x16x32_bf16 v[176:179], v[64:67], v[44:47], 0
    v_mov_b32 v20, v237
    ds_read_b128 v[104:107], v11 offset:12288
    v_mfma_f32_16x16x32_bf16 v[192:195], v[64:67], v[48:51], 0
    v_mov_b32 v23, v238
    v_mfma_f32_16x16x32_bf16 v[196:199], v[68:71], v[48:51], 0
    ds_read_b128 v[108:111], v11 offset:14336
    v_mov_b32 v24, v239
    v_mfma_f32_16x16x32_bf16 v[200:203], v[72:75], v[48:51], 0
    v_mov_b32 v25, v240
    v_mov_b32 v26, v241
    v_mfma_f32_16x16x32_bf16 v[204:207], v[76:79], v[48:51], 0
    v_mov_b32 v27, v242
    v_lshrrev_b32 v15, v15, v18
    v_mfma_f32_16x16x32_bf16 v[220:223], v[76:79], v[52:55], 0
    v_cndmask_b32 v28, 0, v15, s[44:45]
    v_cndmask_b32 v29, 0, v15, s[46:47]
    v_mfma_f32_16x16x32_bf16 v[216:219], v[72:75], v[52:55], 0
    v_cndmask_b32 v30, 0, v15, s[48:49]
    v_mfma_f32_16x16x32_bf16 v[212:215], v[68:71], v[52:55], 0
    v_cndmask_b32 v31, 0, v15, s[50:51]
    v_mov_b32 v8, v250
    v_mfma_f32_16x16x32_bf16 v[208:211], v[64:67], v[52:55], 0
    v_mov_b32 v15, v251
    v_mov_b32 v18, v252
    v_mfma_f32_16x16x32_bf16 v[224:227], v[64:67], v[56:59], 0
    v_mov_b32 v22, v253
    v_add_u32 v10, 4294868992, v10
    v_mfma_f32_16x16x32_bf16 v[228:231], v[68:71], v[56:59], 0
    v_add_u32 v11, 4294868992, v11
    v_add_u32 v12, 4294868992, v12
    v_mfma_f32_16x16x32_bf16 v[232:235], v[72:75], v[56:59], 0
    v_add_u32 v13, 4294868992, v13
    v_mfma_f32_16x16x32_bf16 v[236:239], v[76:79], v[56:59], 0
    v_mfma_f32_16x16x32_bf16 v[252:255], v[76:79], v[60:63], 0
    v_mfma_f32_16x16x32_bf16 v[248:251], v[72:75], v[60:63], 0
    v_mfma_f32_16x16x32_bf16 v[244:247], v[68:71], v[60:63], 0
    v_mfma_f32_16x16x32_bf16 v[240:243], v[64:67], v[60:63], 0
    s_cmp_eq_u32 s7, 9
    s_branch L_g1mid
L_g1loop:
    s_waitcnt lgkmcnt(0)
    v_mfma_f32_16x16x32_bf16 v[128:131], v[64:67], v[32:35], v[128:131]
    ds_read_b64_tr_b16 v[112:113], v12 offset:4096
    v_mfma_f32_16x16x32_bf16 v[132:135], v[68:71], v[32:35], v[132:135]
    ds_read_b64_tr_b16 v[114:115], v12 offset:4608
    v_mfma_f32_16x16x32_bf16 v[136:139], v[72:75], v[32:35], v[136:139]
    ds_read_b64_tr_b16 v[116:117], v13 offset:4096
    v_mfma_f32_16x16x32_bf16 v[140:143], v[76:79], v[32:35], v[140:143]
    ds_read_b64_tr_b16 v[118:119], v13 offset:4608
    v_mfma_f32_16x16x32_bf16 v[156:159], v[76:79], v[36:39], v[156:159]
    ds_read_b64_tr_b16 v[120:121], v12 offset:12288
    v_mfma_f32_16x16x32_bf16 v[152:155], v[72:75], v[36:39], v[152:155]
    ds_read_b64_tr_b16 v[122:123], v12 offset:12800
    v_mfma_f32_16x16x32_bf16 v[148:151], v[68:71], v[36:39], v[148:151]
    ds_read_b64_tr_b16 v[124:125], v13 offset:12288
    v_mfma_f32_16x16x32_bf16 v[144:147], v[64:67], v[36:39], v[144:147]
    ds_read_b64_tr_b16 v[126:127], v13 offset:12800
    v_mfma_f32_16x16x32_bf16 v[160:163], v[64:67], v[40:43], v[160:163]
    ds_read_b128 v[80:83], v11 offset:0
    v_mfma_f32_16x16x32_bf16 v[164:167], v[68:71], v[40:43], v[164:167]
    v_mfma_f32_16x16x32_bf16 v[168:171], v[72:75], v[40:43], v[168:171]
    ds_read_b128 v[84:87], v11 offset:2048
    v_mfma_f32_16x16x32_bf16 v[172:175], v[76:79], v[40:43], v[172:175]
    ds_read_b128 v[88:91], v11 offset:4096
    v_mfma_f32_16x16x32_bf16 v[188:191], v[76:79], v[44:47], v[188:191]
    ds_read_b128 v[92:95], v11 offset:6144
    v_mfma_f32_16x16x32_bf16 v[184:187], v[72:75], v[44:47], v[184:187]
    ds_read_b128 v[96:99], v11 offset:8192
    v_mfma_f32_16x16x32_bf16 v[180:183], v[68:71], v[44:47], v[180:183]
    ds_read_b128 v[100:103], v11 offset:10240
    v_mfma_f32_16x16x32_bf16 v[176:179], v[64:67], v[44:47], v[176:179]
    ds_read_b128 v[104:107], v11 offset:12288
    v_mfma_f32_16x16x32_bf16 v[192:195], v[64:67], v[48:51], v[192:195]
    ds_read_b128 v[108:111], v11 offset:14336
    v_mfma_f32_16x16x32_bf16 v[196:199], v[68:71], v[48:51], v[196:199]
    s_add_u32 s8, s8, 1
    v_mfma_f32_16x16x32_bf16 v[200:203], v[72:75], v[48:51], v[200:203]
    s_cmp_eq_u32 s8, 3
    v_mfma_f32_16x16x32_bf16 v[204:207], v[76:79], v[48:51], v[204:207]
    v_mfma_f32_16x16x32_bf16 v[220:223], v[76:79], v[52:55], v[220:223]
    s_cselect_b32 s8, 0, s8
    v_mfma_f32_16x16x32_bf16 v[216:219], v[72:75], v[52:55], v[216:219]
    s_mov_b32 s9, 49152
    v_mfma_f32_16x16x32_bf16 v[212:215], v[68:71], v[52:55], v[212:215]
    s_cmov_b32 s9, 4294868992
    v_mfma_f32_16x16x32_bf16 v[208:211], v[64:67], v[52:55], v[208:211]
    v_add_u32 v10, s9, v10
    v_mfma_f32_16x16x32_bf16 v[224:227], v[64:67], v[56:59], v[224:227]
    v_add_u32 v11, s9, v11
    v_mfma_f32_16x16x32_bf16 v[228:231], v[68:71], v[56:59], v[228:231]
    v_add_u32 v12, s9, v12
    v_mfma_f32_16x16x32_bf16 v[232:235], v[72:75], v[56:59], v[232:235]
    v_add_u32 v13, s9, v13
    v_mfma_f32_16x16x32_bf16 v[236:239], v[76:79], v[56:59], v[236:239]
    s_add_u32 s7, s7, 1
    v_mfma_f32_16x16x32_bf16 v[252:255], v[76:79], v[60:63], v[252:255]
    s_cmp_eq_u32 s7, 9
    v_mfma_f32_16x16x32_bf16 v[248:251], v[72:75], v[60:63], v[248:251]
    v_mfma_f32_16x16x32_bf16 v[244:247], v[68:71], v[60:63], v[244:247]
    v_mfma_f32_16x16x32_bf16 v[240:243], v[64:67], v[60:63], v[240:243]
L_g1mid:
    s_waitcnt lgkmcnt(0)
    s_barrier
    s_cbranch_scc1 L_g1last
    v_mfma_f32_16x16x32_bf16 v[128:131], v[112:115], v[80:83], v[128:131]
    ds_read_b64_tr_b16 v[64:65], v12 offset:0
    v_mfma_f32_16x16x32_bf16 v[132:135], v[116:119], v[80:83], v[132:135]
    ds_read_b64_tr_b16 v[66:67], v12 offset:512
    v_mfma_f32_16x16x32_bf16 v[136:139], v[120:123], v[80:83], v[136:139]
    v_mfma_f32_16x16x32_bf16 v[140:143], v[124:127], v[80:83], v[140:143]
    ds_read_b64_tr_b16 v[68:69], v13 offset:0
    v_mfma_f32_16x16x32_bf16 v[156:159], v[124:127], v[84:87], v[156:159]
    ds_read_b64_tr_b16 v[70:71], v13 offset:512
    v_mfma_f32_16x16x32_bf16 v[152:155], v[120:123], v[84:87], v[152:155]
    v_mfma_f32_16x16x32_bf16 v[148:151], v[116:119], v[84:87], v[148:151]
    ds_read_b64_tr_b16 v[72:73], v12 offset:8192
    v_mfma_f32_16x16x32_bf16 v[144:147], v[112:115], v[84:87], v[144:147]
    ds_read_b64_tr_b16 v[74:75], v12 offset:8704
    v_mfma_f32_16x16x32_bf16 v[160:163], v[112:115], v[88:91], v[160:163]
    v_mfma_f32_16x16x32_bf16 v[164:167], v[116:119], v[88:91], v[164:167]
    ds_read_b64_tr_b16 v[76:77], v13 offset:8192
    v_mfma_f32_16x16x32_bf16 v[168:171], v[120:123], v[88:91], v[168:171]
    ds_read_b64_tr_b16 v[78:79], v13 offset:8704
    v_mfma_f32_16x16x32_bf16 v[172:175], v[124:127], v[88:91], v[172:175]
    v_mfma_f32_16x16x32_bf16 v[188:191], v[124:127], v[92:95], v[188:191]
    ds_read_b128 v[32:35], v10 offset:0
    v_mfma_f32_16x16x32_bf16 v[184:187], v[120:123], v[92:95], v[184:187]
    ds_read_b128 v[36:39], v10 offset:2048
    v_mfma_f32_16x16x32_bf16 v[180:183], v[116:119], v[92:95], v[180:183]
    v_mfma_f32_16x16x32_bf16 v[176:179], v[112:115], v[92:95], v[176:179]
    ds_read_b128 v[40:43], v10 offset:4096
    v_mfma_f32_16x16x32_bf16 v[192:195], v[112:115], v[96:99], v[192:195]
    ds_read_b128 v[44:47], v10 offset:6144
    v_mfma_f32_16x16x32_bf16 v[196:199], v[116:119], v[96:99], v[196:199]
    v_mfma_f32_16x16x32_bf16 v[200:203], v[120:123], v[96:99], v[200:203]
    ds_read_b128 v[48:51], v10 offset:8192
    v_mfma_f32_16x16x32_bf16 v[204:207], v[124:127], v[96:99], v[204:207]
    ds_read_b128 v[52:55], v10 offset:10240
    v_mfma_f32_16x16x32_bf16 v[220:223], v[124:127], v[100:103], v[220:223]
    v_mfma_f32_16x16x32_bf16 v[216:219], v[120:123], v[100:103], v[216:219]
    ds_read_b128 v[56:59], v10 offset:12288
    v_mfma_f32_16x16x32_bf16 v[212:215], v[116:119], v[100:103], v[212:215]
    ds_read_b128 v[60:63], v10 offset:14336
    v_mfma_f32_16x16x32_bf16 v[208:211], v[112:115], v[100:103], v[208:211]
    v_mfma_f32_16x16x32_bf16 v[224:227], v[112:115], v[104:107], v[224:227]
    v_mfma_f32_16x16x32_bf16 v[228:231], v[116:119], v[104:107], v[228:231]
    v_mfma_f32_16x16x32_bf16 v[232:235], v[120:123], v[104:107], v[232:235]
    v_mfma_f32_16x16x32_bf16 v[236:239], v[124:127], v[104:107], v[236:239]
    v_mfma_f32_16x16x32_bf16 v[252:255], v[124:127], v[108:111], v[252:255]
    v_mfma_f32_16x16x32_bf16 v[248:251], v[120:123], v[108:111], v[248:251]
    v_mfma_f32_16x16x32_bf16 v[244:247], v[116:119], v[108:111], v[244:247]
    v_mfma_f32_16x16x32_bf16 v[240:243], v[112:115], v[108:111], v[240:243]
    s_branch L_g1loop
L_g1last:
    v_mfma_f32_16x16x32_bf16 v[128:131], v[112:115], v[80:83], v[128:131]
    s_lshl_b32 s6, s5, 7
    s_add_u32 s6, s6, 147456
    v_lshl_add_u32 v2, v7, 4, s6
    v_mfma_f32_16x16x32_bf16 v[132:135], v[116:119], v[80:83], v[132:135]
    s_lshl_b32 s6, s4, 11
    s_add_u32 s6, s6, 148480
    v_mfma_f32_16x16x32_bf16 v[136:139], v[120:123], v[80:83], v[136:139]
    v_lshl_add_u32 v3, v6, 4, s6
    ds_read_b128 v[64:67], v2 offset:0
    v_mfma_f32_16x16x32_bf16 v[140:143], v[124:127], v[80:83], v[140:143]
    ds_read_b128 v[68:71], v2 offset:64
    ds_read_b128 v[72:75], v2 offset:256
    v_mfma_f32_16x16x32_bf16 v[156:159], v[124:127], v[84:87], v[156:159]
    ds_read_b128 v[76:79], v2 offset:320
    ds_read_b128 v[32:35], v3 offset:0
    v_mfma_f32_16x16x32_bf16 v[152:155], v[120:123], v[84:87], v[152:155]
    ds_read_b128 v[36:39], v3 offset:256
    ds_read_b128 v[40:43], v3 offset:512
    v_mfma_f32_16x16x32_bf16 v[148:151], v[116:119], v[84:87], v[148:151]
    ds_read_b128 v[44:47], v3 offset:768
    ds_read_b128 v[48:51], v3 offset:1024
    v_mfma_f32_16x16x32_bf16 v[144:147], v[112:115], v[84:87], v[144:147]
    ds_read_b128 v[52:55], v3 offset:1280
    ds_read_b128 v[56:59], v3 offset:1536
    ds_read_b128 v[60:63], v3 offset:1792
    v_mfma_f32_16x16x32_bf16 v[160:163], v[112:115], v[88:91], v[160:163]
    v_lshlrev_b32 v4, 4, v0
    s_add_u32 s56, s42, 5885952
    v_mfma_f32_16x16x32_bf16 v[164:167], v[116:119], v[88:91], v[164:167]
    s_addc_u32 s57, s43, 0
    s_mov_b32 s58, 7077888
    v_mfma_f32_16x16x32_bf16 v[168:171], v[120:123], v[88:91], v[168:171]
    s_mov_b32 s59, 0x20000
    s_add_u32 s84, s42, 15667200
    v_mfma_f32_16x16x32_bf16 v[172:175], v[124:127], v[88:91], v[172:175]
    s_addc_u32 s85, s43, 0
    s_mov_b32 s86, 609280
    v_mfma_f32_16x16x32_bf16 v[188:191], v[124:127], v[92:95], v[188:191]
    s_mov_b32 s87, 0x20000
    s_add_u32 s52, s42, 12963840
    v_mfma_f32_16x16x32_bf16 v[184:187], v[120:123], v[92:95], v[184:187]
    s_addc_u32 s53, s43, 0
    s_mov_b32 s54, 2703360
    v_mfma_f32_16x16x32_bf16 v[180:183], v[116:119], v[92:95], v[180:183]
    s_mov_b32 s55, 0x20000
    s_lshl1_add_u32 s10, s92, s4
    v_mfma_f32_16x16x32_bf16 v[176:179], v[112:115], v[92:95], v[176:179]
    s_mul_i32 s10, s10, 54
    s_lshl1_add_u32 s9, s93, s5
    s_lshl1_add_u32 s6, s10, s9
    v_mfma_f32_16x16x32_bf16 v[192:195], v[112:115], v[96:99], v[192:195]
    s_lshl_b32 s6, s6, 12
    s_add_u32 s10, s10, s9
    v_mfma_f32_16x16x32_bf16 v[196:199], v[116:119], v[96:99], v[196:199]
    s_lshl_b32 s10, s10, 7
    s_add_u32 s10, s10, 48128
    v_mfma_f32_16x16x32_bf16 v[200:203], v[120:123], v[96:99], v[200:203]
    s_add_u32 s68, s42, 3674112
    s_addc_u32 s69, s43, 0
    v_mfma_f32_16x16x32_bf16 v[204:207], v[124:127], v[96:99], v[204:207]
    s_mov_b32 s70, 2211840
    s_mov_b32 s71, 0x20000
    v_mfma_f32_16x16x32_bf16 v[220:223], v[124:127], v[100:103], v[220:223]
    s_mul_i32 s60, s91, 54
    s_add_u32 s60, s60, s3
    v_mfma_f32_16x16x32_bf16 v[216:219], v[120:123], v[100:103], v[216:219]
    s_add_u32 s60, s60, 40
    s_mul_i32 s60, s60, 5120
    v_mfma_f32_16x16x32_bf16 v[212:215], v[116:119], v[100:103], v[212:215]
    v_add_u32 v9, 4096, v4
    v_mov_b32 v12, v1
    v_mov_b32 v13, v5
    v_mfma_f32_16x16x32_bf16 v[208:211], v[112:115], v[100:103], v[208:211]
    s_lshl_b32 s76, s78, 8
    s_lshl_b32 s77, s78, 4
    v_mfma_f32_16x16x32_bf16 v[224:227], v[112:115], v[104:107], v[224:227]
    s_sub_u32 s77, s76, s77
    v_add_u32 v2, s77, v13
    v_mfma_f32_16x16x32_bf16 v[228:231], v[116:119], v[104:107], v[228:231]
    s_mul_i32 s77, s78, 160
    s_sub_u32 s77, s77, s76
    v_mfma_f32_16x16x32_bf16 v[232:235], v[120:123], v[104:107], v[232:235]
    s_add_u32 s77, s77, 2216
    v_lshl_add_u32 v3, v7, 3, v12
    v_mfma_f32_16x16x32_bf16 v[236:239], v[124:127], v[104:107], v[236:239]
    v_add_u32 v3, s77, v3
    s_mul_i32 s77, s78, 192
    v_mfma_f32_16x16x32_bf16 v[252:255], v[124:127], v[108:111], v[252:255]
    v_subrev_u32 v10, s77, v12
    s_waitcnt lgkmcnt(0)
    v_mfma_f32_16x16x32_bf16 v[248:251], v[120:123], v[108:111], v[248:251]
    v_readfirstlane_b32 s95, v35
    v_mov_b32 v17, v35
    v_mfma_f32_16x16x32_bf16 v[244:247], v[116:119], v[108:111], v[244:247]
    v_mfma_f32_16x16x32_bf16 v[240:243], v[112:115], v[108:111], v[240:243]
    v_pk_fma_f32 v[128:129], v[64:65], v[32:33], v[128:129] op_sel_hi:[1,0,1] neg_lo:[0,1,0] neg_hi:[0,1,0]
    v_pk_fma_f32 v[130:131], v[66:67], v[32:33], v[130:131] op_sel_hi:[1,0,1] neg_lo:[0,1,0] neg_hi:[0,1,0]
    v_pk_fma_f32 v[132:133], v[68:69], v[32:33], v[132:133] op_sel_hi:[1,0,1] neg_lo:[0,1,0] neg_hi:[0,1,0]
    v_pk_fma_f32 v[134:135], v[70:71], v[32:33], v[134:135] op_sel_hi:[1,0,1] neg_lo:[0,1,0] neg_hi:[0,1,0]
    v_pk_mul_f32 v[80:81], v[128:129], v[32:33] op_sel:[0,1] op_sel_hi:[1,1]
    v_pk_mul_f32 v[82:83], v[130:131], v[32:33] op_sel:[0,1] op_sel_hi:[1,1]
    v_pk_mul_f32 v[84:85], v[132:133], v[32:33] op_sel:[0,1] op_sel_hi:[1,1]
    v_pk_mul_f32 v[86:87], v[134:135], v[32:33] op_sel:[0,1] op_sel_hi:[1,1]
    v_exp_f32 v80, v80
    v_exp_f32 v81, v81
    v_exp_f32 v82, v82
    v_exp_f32 v83, v83
    v_exp_f32 v84, v84
    v_exp_f32 v85, v85
    v_exp_f32 v86, v86
    v_exp_f32 v87, v87
    v_pk_fma_f32 v[136:137], v[72:73], v[32:33], v[136:137] op_sel_hi:[1,0,1] neg_lo:[0,1,0] neg_hi:[0,1,0]
    v_pk_fma_f32 v[138:139], v[74:75], v[32:33], v[138:139] op_sel_hi:[1,0,1] neg_lo:[0,1,0] neg_hi:[0,1,0]
    v_pk_fma_f32 v[140:141], v[76:77], v[32:33], v[140:141] op_sel_hi:[1,0,1] neg_lo:[0,1,0] neg_hi:[0,1,0]
    v_pk_fma_f32 v[142:143], v[78:79], v[32:33], v[142:143] op_sel_hi:[1,0,1] neg_lo:[0,1,0] neg_hi:[0,1,0]
    v_pk_fma_f32 v[80:81], v[80:81], v[34:35], v[34:35] op_sel_hi:[1,0,0]
    v_pk_fma_f32 v[82:83], v[82:83], v[34:35], v[34:35] op_sel_hi:[1,0,0]
    v_pk_fma_f32 v[84:85], v[84:85], v[34:35], v[34:35] op_sel_hi:[1,0,0]
    v_pk_fma_f32 v[86:87], v[86:87], v[34:35], v[34:35] op_sel_hi:[1,0,0]
    v_rcp_f32 v80, v80
    v_rcp_f32 v81, v81
    v_rcp_f32 v82, v82
    v_rcp_f32 v83, v83
    v_rcp_f32 v84, v84
    v_rcp_f32 v85, v85
    v_rcp_f32 v86, v86
    v_rcp_f32 v87, v87
    v_pk_mul_f32 v[128:129], v[128:129], v[136:137]
    v_pk_mul_f32 v[130:131], v[130:131], v[138:139]
    v_pk_mul_f32 v[132:133], v[132:133], v[140:141]
    v_pk_mul_f32 v[134:135], v[134:135], v[142:143]
    v_pk_mul_f32 v[128:129], v[128:129], v[80:81]
    v_pk_mul_f32 v[130:131], v[130:131], v[82:83]
    v_pk_mul_f32 v[132:133], v[132:133], v[84:85]
    v_pk_mul_f32 v[134:135], v[134:135], v[86:87]
    v_cvt_pk_bf16_f32 v112, v128, v129
    v_cvt_pk_bf16_f32 v113, v130, v131
    v_cvt_pk_bf16_f32 v114, v132, v133
    v_cvt_pk_bf16_f32 v115, v134, v135
    buffer_store_dwordx4 v[112:115], v4, s[56:59], s6 offen offset:0 sc1
    v_pk_fma_f32 v[144:145], v[64:65], v[36:37], v[144:145] op_sel_hi:[1,0,1] neg_lo:[0,1,0] neg_hi:[0,1,0]
    v_pk_fma_f32 v[146:147], v[66:67], v[36:37], v[146:147] op_sel_hi:[1,0,1] neg_lo:[0,1,0] neg_hi:[0,1,0]
    v_pk_fma_f32 v[148:149], v[68:69], v[36:37], v[148:149] op_sel_hi:[1,0,1] neg_lo:[0,1,0] neg_hi:[0,1,0]
    v_pk_fma_f32 v[150:151], v[70:71], v[36:37], v[150:151] op_sel_hi:[1,0,1] neg_lo:[0,1,0] neg_hi:[0,1,0]
    v_pk_mul_f32 v[88:89], v[144:145], v[36:37] op_sel:[0,1] op_sel_hi:[1,1]
    v_pk_mul_f32 v[90:91], v[146:147], v[36:37] op_sel:[0,1] op_sel_hi:[1,1]
    v_pk_mul_f32 v[92:93], v[148:149], v[36:37] op_sel:[0,1] op_sel_hi:[1,1]
    v_pk_mul_f32 v[94:95], v[150:151], v[36:37] op_sel:[0,1] op_sel_hi:[1,1]
    v_exp_f32 v88, v88
    v_exp_f32 v89, v89
    v_exp_f32 v90, v90
    v_exp_f32 v91, v91
    v_exp_f32 v92, v92
    v_exp_f32 v93, v93
    v_exp_f32 v94, v94
    v_exp_f32 v95, v95
    v_pk_fma_f32 v[152:153], v[72:73], v[36:37], v[152:153] op_sel_hi:[1,0,1] neg_lo:[0,1,0] neg_hi:[0,1,0]
    v_pk_fma_f32 v[154:155], v[74:75], v[36:37], v[154:155] op_sel_hi:[1,0,1] neg_lo:[0,1,0] neg_hi:[0,1,0]
    v_pk_fma_f32 v[156:157], v[76:77], v[36:37], v[156:157] op_sel_hi:[1,0,1] neg_lo:[0,1,0] neg_hi:[0,1,0]
    v_pk_fma_f32 v[158:159], v[78:79], v[36:37], v[158:159] op_sel_hi:[1,0,1] neg_lo:[0,1,0] neg_hi:[0,1,0]
    v_pk_fma_f32 v[88:89], v[88:89], v[38:39], v[38:39] op_sel_hi:[1,0,0]
    v_pk_fma_f32 v[90:91], v[90:91], v[38:39], v[38:39] op_sel_hi:[1,0,0]
    v_pk_fma_f32 v[92:93], v[92:93], v[38:39], v[38:39] op_sel_hi:[1,0,0]
    v_pk_fma_f32 v[94:95], v[94:95], v[38:39], v[38:39] op_sel_hi:[1,0,0]
    v_rcp_f32 v88, v88
    v_rcp_f32 v89, v89
    v_rcp_f32 v90, v90
    v_rcp_f32 v91, v91
    v_rcp_f32 v92, v92
    v_rcp_f32 v93, v93
    v_rcp_f32 v94, v94
    v_rcp_f32 v95, v95
    v_pk_mul_f32 v[144:145], v[144:145], v[152:153]
    v_pk_mul_f32 v[146:147], v[146:147], v[154:155]
    v_pk_mul_f32 v[148:149], v[148:149], v[156:157]
    v_pk_mul_f32 v[150:151], v[150:151], v[158:159]
    v_pk_mul_f32 v[144:145], v[144:145], v[88:89]
    v_pk_mul_f32 v[146:147], v[146:147], v[90:91]
    v_pk_mul_f32 v[148:149], v[148:149], v[92:93]
    v_pk_mul_f32 v[150:151], v[150:151], v[94:95]
    v_cvt_pk_bf16_f32 v116, v144, v145
    v_cvt_pk_bf16_f32 v117, v146, v147
    v_cvt_pk_bf16_f32 v118, v148, v149
    v_cvt_pk_bf16_f32 v119, v150, v151
    buffer_store_dwordx4 v[116:119], v4, s[56:59], s6 offen offset:1024 sc1
    v_pk_fma_f32 v[160:161], v[64:65], v[40:41], v[160:161] op_sel_hi:[1,0,1] neg_lo:[0,1,0] neg_hi:[0,1,0]
    v_pk_fma_f32 v[162:163], v[66:67], v[40:41], v[162:163] op_sel_hi:[1,0,1] neg_lo:[0,1,0] neg_hi:[0,1,0]
    v_pk_fma_f32 v[164:165], v[68:69], v[40:41], v[164:165] op_sel_hi:[1,0,1] neg_lo:[0,1,0] neg_hi:[0,1,0]
    v_pk_fma_f32 v[166:167], v[70:71], v[40:41], v[166:167] op_sel_hi:[1,0,1] neg_lo:[0,1,0] neg_hi:[0,1,0]
    v_pk_mul_f32 v[80:81], v[160:161], v[40:41] op_sel:[0,1] op_sel_hi:[1,1]
    v_pk_mul_f32 v[82:83], v[162:163], v[40:41] op_sel:[0,1] op_sel_hi:[1,1]
    v_pk_mul_f32 v[84:85], v[164:165], v[40:41] op_sel:[0,1] op_sel_hi:[1,1]
    v_pk_mul_f32 v[86:87], v[166:167], v[40:41] op_sel:[0,1] op_sel_hi:[1,1]
    v_exp_f32 v80, v80
    v_exp_f32 v81, v81
    v_exp_f32 v82, v82
    v_exp_f32 v83, v83
    v_exp_f32 v84, v84
    v_exp_f32 v85, v85
    v_exp_f32 v86, v86
    v_exp_f32 v87, v87
    v_pk_fma_f32 v[168:169], v[72:73], v[40:41], v[168:169] op_sel_hi:[1,0,1] neg_lo:[0,1,0] neg_hi:[0,1,0]
    v_pk_fma_f32 v[170:171], v[74:75], v[40:41], v[170:171] op_sel_hi:[1,0,1] neg_lo:[0,1,0] neg_hi:[0,1,0]
    v_pk_fma_f32 v[172:173], v[76:77], v[40:41], v[172:173] op_sel_hi:[1,0,1] neg_lo:[0,1,0] neg_hi:[0,1,0]
    v_pk_fma_f32 v[174:175], v[78:79], v[40:41], v[174:175] op_sel_hi:[1,0,1] neg_lo:[0,1,0] neg_hi:[0,1,0]
    v_pk_fma_f32 v[80:81], v[80:81], v[42:43], v[42:43] op_sel_hi:[1,0,0]
    v_pk_fma_f32 v[82:83], v[82:83], v[42:43], v[42:43] op_sel_hi:[1,0,0]
    v_pk_fma_f32 v[84:85], v[84:85], v[42:43], v[42:43] op_sel_hi:[1,0,0]
    v_pk_fma_f32 v[86:87], v[86:87], v[42:43], v[42:43] op_sel_hi:[1,0,0]
    v_rcp_f32 v80, v80
    v_rcp_f32 v81, v81
    v_rcp_f32 v82, v82
    v_rcp_f32 v83, v83
    v_rcp_f32 v84, v84
    v_rcp_f32 v85, v85
    v_rcp_f32 v86, v86
    v_rcp_f32 v87, v87
    v_pk_mul_f32 v[160:161], v[160:161], v[168:169]
    v_pk_mul_f32 v[162:163], v[162:163], v[170:171]
    v_pk_mul_f32 v[164:165], v[164:165], v[172:173]
    v_pk_mul_f32 v[166:167], v[166:167], v[174:175]
    v_pk_mul_f32 v[160:161], v[160:161], v[80:81]
    v_pk_mul_f32 v[162:163], v[162:163], v[82:83]
    v_pk_mul_f32 v[164:165], v[164:165], v[84:85]
    v_pk_mul_f32 v[166:167], v[166:167], v[86:87]
    v_cvt_pk_bf16_f32 v120, v160, v161
    v_cvt_pk_bf16_f32 v121, v162, v163
    v_cvt_pk_bf16_f32 v122, v164, v165
    v_cvt_pk_bf16_f32 v123, v166, v167
    buffer_store_dwordx4 v[120:123], v4, s[56:59], s6 offen offset:2048 sc1
    v_pk_fma_f32 v[176:177], v[64:65], v[44:45], v[176:177] op_sel_hi:[1,0,1] neg_lo:[0,1,0] neg_hi:[0,1,0]
    v_pk_fma_f32 v[178:179], v[66:67], v[44:45], v[178:179] op_sel_hi:[1,0,1] neg_lo:[0,1,0] neg_hi:[0,1,0]
    v_pk_fma_f32 v[180:181], v[68:69], v[44:45], v[180:181] op_sel_hi:[1,0,1] neg_lo:[0,1,0] neg_hi:[0,1,0]
    v_pk_fma_f32 v[182:183], v[70:71], v[44:45], v[182:183] op_sel_hi:[1,0,1] neg_lo:[0,1,0] neg_hi:[0,1,0]
    v_pk_mul_f32 v[88:89], v[176:177], v[44:45] op_sel:[0,1] op_sel_hi:[1,1]
    v_pk_mul_f32 v[90:91], v[178:179], v[44:45] op_sel:[0,1] op_sel_hi:[1,1]
    v_pk_mul_f32 v[92:93], v[180:181], v[44:45] op_sel:[0,1] op_sel_hi:[1,1]
    v_pk_mul_f32 v[94:95], v[182:183], v[44:45] op_sel:[0,1] op_sel_hi:[1,1]
    v_exp_f32 v88, v88
    v_exp_f32 v89, v89
    v_exp_f32 v90, v90
    v_exp_f32 v91, v91
    v_exp_f32 v92, v92
    v_exp_f32 v93, v93
    v_exp_f32 v94, v94
    v_exp_f32 v95, v95
    v_pk_fma_f32 v[184:185], v[72:73], v[44:45], v[184:185] op_sel_hi:[1,0,1] neg_lo:[0,1,0] neg_hi:[0,1,0]
    v_pk_fma_f32 v[186:187], v[74:75], v[44:45], v[186:187] op_sel_hi:[1,0,1] neg_lo:[0,1,0] neg_hi:[0,1,0]
    v_pk_fma_f32 v[188:189], v[76:77], v[44:45], v[188:189] op_sel_hi:[1,0,1] neg_lo:[0,1,0] neg_hi:[0,1,0]
    v_pk_fma_f32 v[190:191], v[78:79], v[44:45], v[190:191] op_sel_hi:[1,0,1] neg_lo:[0,1,0] neg_hi:[0,1,0]
    v_pk_fma_f32 v[88:89], v[88:89], v[46:47], v[46:47] op_sel_hi:[1,0,0]
    v_pk_fma_f32 v[90:91], v[90:91], v[46:47], v[46:47] op_sel_hi:[1,0,0]
    v_pk_fma_f32 v[92:93], v[92:93], v[46:47], v[46:47] op_sel_hi:[1,0,0]
    v_pk_fma_f32 v[94:95], v[94:95], v[46:47], v[46:47] op_sel_hi:[1,0,0]
    v_rcp_f32 v88, v88
    v_rcp_f32 v89, v89
    v_rcp_f32 v90, v90
    v_rcp_f32 v91, v91
    v_rcp_f32 v92, v92
    v_rcp_f32 v93, v93
    v_rcp_f32 v94, v94
    v_rcp_f32 v95, v95
    v_pk_mul_f32 v[176:177], v[176:177], v[184:185]
    v_pk_mul_f32 v[178:179], v[178:179], v[186:187]
    v_pk_mul_f32 v[180:181], v[180:181], v[188:189]
    v_pk_mul_f32 v[182:183], v[182:183], v[190:191]
    v_pk_mul_f32 v[176:177], v[176:177], v[88:89]
    v_pk_mul_f32 v[178:179], v[178:179], v[90:91]
    v_pk_mul_f32 v[180:181], v[180:181], v[92:93]
    v_pk_mul_f32 v[182:183], v[182:183], v[94:95]
    v_cvt_pk_bf16_f32 v124, v176, v177
    v_cvt_pk_bf16_f32 v125, v178, v179
    v_cvt_pk_bf16_f32 v126, v180, v181
    v_cvt_pk_bf16_f32 v127, v182, v183
    buffer_store_dwordx4 v[124:127], v4, s[56:59], s6 offen offset:3072 sc1
    s_add_u32 s6, s6, 221184
    v_pk_fma_f32 v[192:193], v[64:65], v[48:49], v[192:193] op_sel_hi:[1,0,1] neg_lo:[0,1,0] neg_hi:[0,1,0]
    v_pk_fma_f32 v[194:195], v[66:67], v[48:49], v[194:195] op_sel_hi:[1,0,1] neg_lo:[0,1,0] neg_hi:[0,1,0]
    v_pk_fma_f32 v[196:197], v[68:69], v[48:49], v[196:197] op_sel_hi:[1,0,1] neg_lo:[0,1,0] neg_hi:[0,1,0]
    v_pk_fma_f32 v[198:199], v[70:71], v[48:49], v[198:199] op_sel_hi:[1,0,1] neg_lo:[0,1,0] neg_hi:[0,1,0]
    v_pk_mul_f32 v[80:81], v[192:193], v[48:49] op_sel:[0,1] op_sel_hi:[1,1]
    v_pk_mul_f32 v[82:83], v[194:195], v[48:49] op_sel:[0,1] op_sel_hi:[1,1]
    v_pk_mul_f32 v[84:85], v[196:197], v[48:49] op_sel:[0,1] op_sel_hi:[1,1]
    v_pk_mul_f32 v[86:87], v[198:199], v[48:49] op_sel:[0,1] op_sel_hi:[1,1]
    v_exp_f32 v80, v80
    v_exp_f32 v81, v81
    v_exp_f32 v82, v82
    v_exp_f32 v83, v83
    v_exp_f32 v84, v84
    v_exp_f32 v85, v85
    v_exp_f32 v86, v86
    v_exp_f32 v87, v87
    v_pk_fma_f32 v[200:201], v[72:73], v[48:49], v[200:201] op_sel_hi:[1,0,1] neg_lo:[0,1,0] neg_hi:[0,1,0]
    v_pk_fma_f32 v[202:203], v[74:75], v[48:49], v[202:203] op_sel_hi:[1,0,1] neg_lo:[0,1,0] neg_hi:[0,1,0]
    v_pk_fma_f32 v[204:205], v[76:77], v[48:49], v[204:205] op_sel_hi:[1,0,1] neg_lo:[0,1,0] neg_hi:[0,1,0]
    v_pk_fma_f32 v[206:207], v[78:79], v[48:49], v[206:207] op_sel_hi:[1,0,1] neg_lo:[0,1,0] neg_hi:[0,1,0]
    v_pk_fma_f32 v[80:81], v[80:81], v[50:51], v[50:51] op_sel_hi:[1,0,0]
    v_pk_fma_f32 v[82:83], v[82:83], v[50:51], v[50:51] op_sel_hi:[1,0,0]
    v_pk_fma_f32 v[84:85], v[84:85], v[50:51], v[50:51] op_sel_hi:[1,0,0]
    v_pk_fma_f32 v[86:87], v[86:87], v[50:51], v[50:51] op_sel_hi:[1,0,0]
    v_rcp_f32 v80, v80
    v_rcp_f32 v81, v81
    v_rcp_f32 v82, v82
    v_rcp_f32 v83, v83
    v_rcp_f32 v84, v84
    v_rcp_f32 v85, v85
    v_rcp_f32 v86, v86
    v_rcp_f32 v87, v87
    v_pk_mul_f32 v[192:193], v[192:193], v[200:201]
    v_pk_mul_f32 v[194:195], v[194:195], v[202:203]
    v_pk_mul_f32 v[196:197], v[196:197], v[204:205]
    v_pk_mul_f32 v[198:199], v[198:199], v[206:207]
    v_pk_mul_f32 v[192:193], v[192:193], v[80:81]
    v_pk_mul_f32 v[194:195], v[194:195], v[82:83]
    v_pk_mul_f32 v[196:197], v[196:197], v[84:85]
    v_pk_mul_f32 v[198:199], v[198:199], v[86:87]
    v_cvt_pk_bf16_f32 v112, v192, v193
    v_cvt_pk_bf16_f32 v113, v194, v195
    v_cvt_pk_bf16_f32 v114, v196, v197
    v_cvt_pk_bf16_f32 v115, v198, v199
    buffer_store_dwordx4 v[112:115], v4, s[56:59], s6 offen offset:0 sc1
    v_pk_fma_f32 v[208:209], v[64:65], v[52:53], v[208:209] op_sel_hi:[1,0,1] neg_lo:[0,1,0] neg_hi:[0,1,0]
    v_pk_fma_f32 v[210:211], v[66:67], v[52:53], v[210:211] op_sel_hi:[1,0,1] neg_lo:[0,1,0] neg_hi:[0,1,0]
    v_pk_fma_f32 v[212:213], v[68:69], v[52:53], v[212:213] op_sel_hi:[1,0,1] neg_lo:[0,1,0] neg_hi:[0,1,0]
    v_pk_fma_f32 v[214:215], v[70:71], v[52:53], v[214:215] op_sel_hi:[1,0,1] neg_lo:[0,1,0] neg_hi:[0,1,0]
    v_pk_mul_f32 v[88:89], v[208:209], v[52:53] op_sel:[0,1] op_sel_hi:[1,1]
    v_pk_mul_f32 v[90:91], v[210:211], v[52:53] op_sel:[0,1] op_sel_hi:[1,1]
    v_pk_mul_f32 v[92:93], v[212:213], v[52:53] op_sel:[0,1] op_sel_hi:[1,1]
    v_pk_mul_f32 v[94:95], v[214:215], v[52:53] op_sel:[0,1] op_sel_hi:[1,1]
    v_exp_f32 v88, v88
    v_exp_f32 v89, v89
    v_exp_f32 v90, v90
    v_exp_f32 v91, v91
    v_exp_f32 v92, v92
    v_exp_f32 v93, v93
    v_exp_f32 v94, v94
    v_exp_f32 v95, v95
    v_pk_fma_f32 v[216:217], v[72:73], v[52:53], v[216:217] op_sel_hi:[1,0,1] neg_lo:[0,1,0] neg_hi:[0,1,0]
    v_pk_fma_f32 v[218:219], v[74:75], v[52:53], v[218:219] op_sel_hi:[1,0,1] neg_lo:[0,1,0] neg_hi:[0,1,0]
    v_pk_fma_f32 v[220:221], v[76:77], v[52:53], v[220:221] op_sel_hi:[1,0,1] neg_lo:[0,1,0] neg_hi:[0,1,0]
    v_pk_fma_f32 v[222:223], v[78:79], v[52:53], v[222:223] op_sel_hi:[1,0,1] neg_lo:[0,1,0] neg_hi:[0,1,0]
    v_pk_fma_f32 v[88:89], v[88:89], v[54:55], v[54:55] op_sel_hi:[1,0,0]
    v_pk_fma_f32 v[90:91], v[90:91], v[54:55], v[54:55] op_sel_hi:[1,0,0]
    v_pk_fma_f32 v[92:93], v[92:93], v[54:55], v[54:55] op_sel_hi:[1,0,0]
    v_pk_fma_f32 v[94:95], v[94:95], v[54:55], v[54:55] op_sel_hi:[1,0,0]
    v_rcp_f32 v88, v88
    v_rcp_f32 v89, v89
    v_rcp_f32 v90, v90
    v_rcp_f32 v91, v91
    v_rcp_f32 v92, v92
    v_rcp_f32 v93, v93
    v_rcp_f32 v94, v94
    v_rcp_f32 v95, v95
    v_pk_mul_f32 v[208:209], v[208:209], v[216:217]
    v_pk_mul_f32 v[210:211], v[210:211], v[218:219]
    v_pk_mul_f32 v[212:213], v[212:213], v[220:221]
    v_pk_mul_f32 v[214:215], v[214:215], v[222:223]
    v_pk_mul_f32 v[208:209], v[208:209], v[88:89]
    v_pk_mul_f32 v[210:211], v[210:211], v[90:91]
    v_pk_mul_f32 v[212:213], v[212:213], v[92:93]
    v_pk_mul_f32 v[214:215], v[214:215], v[94:95]
    v_cvt_pk_bf16_f32 v116, v208, v209
    v_cvt_pk_bf16_f32 v117, v210, v211
    v_cvt_pk_bf16_f32 v118, v212, v213
    v_cvt_pk_bf16_f32 v119, v214, v215
    buffer_store_dwordx4 v[116:119], v4, s[56:59], s6 offen offset:1024 sc1
    v_pk_fma_f32 v[224:225], v[64:65], v[56:57], v[224:225] op_sel_hi:[1,0,1] neg_lo:[0,1,0] neg_hi:[0,1,0]
    v_pk_fma_f32 v[226:227], v[66:67], v[56:57], v[226:227] op_sel_hi:[1,0,1] neg_lo:[0,1,0] neg_hi:[0,1,0]
    v_pk_fma_f32 v[228:229], v[68:69], v[56:57], v[228:229] op_sel_hi:[1,0,1] neg_lo:[0,1,0] neg_hi:[0,1,0]
    v_pk_fma_f32 v[230:231], v[70:71], v[56:57], v[230:231] op_sel_hi:[1,0,1] neg_lo:[0,1,0] neg_hi:[0,1,0]
    v_pk_mul_f32 v[80:81], v[224:225], v[56:57] op_sel:[0,1] op_sel_hi:[1,1]
    v_pk_mul_f32 v[82:83], v[226:227], v[56:57] op_sel:[0,1] op_sel_hi:[1,1]
    v_pk_mul_f32 v[84:85], v[228:229], v[56:57] op_sel:[0,1] op_sel_hi:[1,1]
    v_pk_mul_f32 v[86:87], v[230:231], v[56:57] op_sel:[0,1] op_sel_hi:[1,1]
    v_exp_f32 v80, v80
    v_exp_f32 v81, v81
    v_exp_f32 v82, v82
    v_exp_f32 v83, v83
    v_exp_f32 v84, v84
    v_exp_f32 v85, v85
    v_exp_f32 v86, v86
    v_exp_f32 v87, v87
    v_pk_fma_f32 v[232:233], v[72:73], v[56:57], v[232:233] op_sel_hi:[1,0,1] neg_lo:[0,1,0] neg_hi:[0,1,0]
    v_pk_fma_f32 v[234:235], v[74:75], v[56:57], v[234:235] op_sel_hi:[1,0,1] neg_lo:[0,1,0] neg_hi:[0,1,0]
    v_pk_fma_f32 v[236:237], v[76:77], v[56:57], v[236:237] op_sel_hi:[1,0,1] neg_lo:[0,1,0] neg_hi:[0,1,0]
    v_pk_fma_f32 v[238:239], v[78:79], v[56:57], v[238:239] op_sel_hi:[1,0,1] neg_lo:[0,1,0] neg_hi:[0,1,0]
    v_pk_fma_f32 v[80:81], v[80:81], v[58:59], v[58:59] op_sel_hi:[1,0,0]
    v_pk_fma_f32 v[82:83], v[82:83], v[58:59], v[58:59] op_sel_hi:[1,0,0]
    v_pk_fma_f32 v[84:85], v[84:85], v[58:59], v[58:59] op_sel_hi:[1,0,0]
    v_pk_fma_f32 v[86:87], v[86:87], v[58:59], v[58:59] op_sel_hi:[1,0,0]
    v_rcp_f32 v80, v80
    v_rcp_f32 v81, v81
    v_rcp_f32 v82, v82
    v_rcp_f32 v83, v83
    v_rcp_f32 v84, v84
    v_rcp_f32 v85, v85
    v_rcp_f32 v86, v86
    v_rcp_f32 v87, v87
    v_pk_mul_f32 v[224:225], v[224:225], v[232:233]
    v_pk_mul_f32 v[226:227], v[226:227], v[234:235]
    v_pk_mul_f32 v[228:229], v[228:229], v[236:237]
    v_pk_mul_f32 v[230:231], v[230:231], v[238:239]
    v_pk_mul_f32 v[224:225], v[224:225], v[80:81]
    v_pk_mul_f32 v[226:227], v[226:227], v[82:83]
    v_pk_mul_f32 v[228:229], v[228:229], v[84:85]
    v_pk_mul_f32 v[230:231], v[230:231], v[86:87]
    v_cvt_pk_bf16_f32 v120, v224, v225
    v_cvt_pk_bf16_f32 v121, v226, v227
    v_cvt_pk_bf16_f32 v122, v228, v229
    v_cvt_pk_bf16_f32 v123, v230, v231
    buffer_store_dwordx4 v[120:123], v4, s[56:59], s6 offen offset:2048 sc1
    ds_read_b32 v21, v20
    v_pk_fma_f32 v[240:241], v[64:65], v[60:61], v[240:241] op_sel_hi:[1,0,1] neg_lo:[0,1,0] neg_hi:[0,1,0]
    v_pk_fma_f32 v[242:243], v[66:67], v[60:61], v[242:243] op_sel_hi:[1,0,1] neg_lo:[0,1,0] neg_hi:[0,1,0]
    v_pk_fma_f32 v[244:245], v[68:69], v[60:61], v[244:245] op_sel_hi:[1,0,1] neg_lo:[0,1,0] neg_hi:[0,1,0]
    v_pk_fma_f32 v[246:247], v[70:71], v[60:61], v[246:247] op_sel_hi:[1,0,1] neg_lo:[0,1,0] neg_hi:[0,1,0]
    v_pk_mul_f32 v[88:89], v[240:241], v[60:61] op_sel:[0,1] op_sel_hi:[1,1]
    v_pk_mul_f32 v[90:91], v[242:243], v[60:61] op_sel:[0,1] op_sel_hi:[1,1]
    v_pk_mul_f32 v[92:93], v[244:245], v[60:61] op_sel:[0,1] op_sel_hi:[1,1]
    v_pk_mul_f32 v[94:95], v[246:247], v[60:61] op_sel:[0,1] op_sel_hi:[1,1]
    v_exp_f32 v88, v88
    v_exp_f32 v89, v89
    v_exp_f32 v90, v90
    v_exp_f32 v91, v91
    v_exp_f32 v92, v92
    v_exp_f32 v93, v93
    v_exp_f32 v94, v94
    v_exp_f32 v95, v95
    v_pk_fma_f32 v[248:249], v[72:73], v[60:61], v[248:249] op_sel_hi:[1,0,1] neg_lo:[0,1,0] neg_hi:[0,1,0]
    v_pk_fma_f32 v[250:251], v[74:75], v[60:61], v[250:251] op_sel_hi:[1,0,1] neg_lo:[0,1,0] neg_hi:[0,1,0]
    v_pk_fma_f32 v[252:253], v[76:77], v[60:61], v[252:253] op_sel_hi:[1,0,1] neg_lo:[0,1,0] neg_hi:[0,1,0]
    v_pk_fma_f32 v[254:255], v[78:79], v[60:61], v[254:255] op_sel_hi:[1,0,1] neg_lo:[0,1,0] neg_hi:[0,1,0]
    v_pk_fma_f32 v[88:89], v[88:89], v[62:63], v[62:63] op_sel_hi:[1,0,0]
    v_pk_fma_f32 v[90:91], v[90:91], v[62:63], v[62:63] op_sel_hi:[1,0,0]
    v_pk_fma_f32 v[92:93], v[92:93], v[62:63], v[62:63] op_sel_hi:[1,0,0]
    v_pk_fma_f32 v[94:95], v[94:95], v[62:63], v[62:63] op_sel_hi:[1,0,0]
    v_rcp_f32 v88, v88
    v_rcp_f32 v89, v89
    v_rcp_f32 v90, v90
    v_rcp_f32 v91, v91
    v_rcp_f32 v92, v92
    v_rcp_f32 v93, v93
    v_rcp_f32 v94, v94
    v_rcp_f32 v95, v95
    v_pk_mul_f32 v[240:241], v[240:241], v[248:249]
    v_pk_mul_f32 v[242:243], v[242:243], v[250:251]
    v_pk_mul_f32 v[244:245], v[244:245], v[252:253]
    v_pk_mul_f32 v[246:247], v[246:247], v[254:255]
    v_pk_mul_f32 v[240:241], v[240:241], v[88:89]
    v_pk_mul_f32 v[242:243], v[242:243], v[90:91]
    v_pk_mul_f32 v[244:245], v[244:245], v[92:93]
    v_pk_mul_f32 v[246:247], v[246:247], v[94:95]
    v_cvt_pk_bf16_f32 v124, v240, v241
    v_cvt_pk_bf16_f32 v125, v242, v243
    v_cvt_pk_bf16_f32 v126, v244, v245
    v_cvt_pk_bf16_f32 v127, v246, v247
    buffer_store_dwordx4 v[124:127], v4, s[56:59], s6 offen offset:3072 sc1
    s_waitcnt lgkmcnt(0)
L_in_1:
    v_cmp_ne_u32 vcc, s95, v21
    s_cmp_eq_u64 vcc, 0
    s_cbranch_scc1 L_in_2
    s_add_u32 s89, s89, 1
    s_cmp_ge_u32 s89, 400000
    s_cbranch_scc1 L_in_2
    s_sleep 1
    ds_read_b32 v21, v20
    s_waitcnt lgkmcnt(0)
    s_branch L_in_1
L_in_2:
    ds_read_b128 v[144:147], v13 offset:0
    ds_read_b64_tr_b16 v[128:129], v12 offset:8
    ds_read_b64_tr_b16 v[130:131], v12 offset:0
    ds_read_b128 v[148:151], v13 offset:512
    ds_read_b64_tr_b16 v[132:133], v12 offset:520
    ds_read_b64_tr_b16 v[134:135], v12 offset:512
    ds_read_b128 v[152:155], v13 offset:1024
    ds_read_b64_tr_b16 v[136:137], v12 offset:1032
    ds_read_b64_tr_b16 v[138:139], v12 offset:1024
    s_waitcnt lgkmcnt(6)
    v_mfma_f32_16x16x32_bf16 v[32:35], v[28:31], v[144:147], 0
    ds_read_b128 v[156:159], v13 offset:1536
    ds_read_b64_tr_b16 v[140:141], v12 offset:1544
    v_mfma_f32_16x16x32_bf16 v[32:35], v[128:131], v[144:147], v[32:35]
    ds_read_b64_tr_b16 v[142:143], v12 offset:1536
    ds_read_b64_tr_b16 v[252:253], v10 offset:2056
    s_waitcnt lgkmcnt(7)
    v_mfma_f32_16x16x32_bf16 v[36:39], v[28:31], v[148:151], 0
    ds_read_b64_tr_b16 v[254:255], v10 offset:2048
    ds_read_b128 v[160:163], v13 offset:2048
    v_mfma_f32_16x16x32_bf16 v[36:39], v[128:131], v[148:151], v[36:39]
    ds_read_b128 v[164:167], v13 offset:2560
    ds_read_b128 v[168:171], v13 offset:3072
    v_mfma_f32_16x16x32_bf16 v[36:39], v[132:135], v[144:147], v[36:39]
    ds_read_b128 v[172:175], v13 offset:3584
    v_add_u32 v12, 64, v12
    s_waitcnt lgkmcnt(9)
    v_mfma_f32_16x16x32_bf16 v[40:43], v[28:31], v[152:155], 0
    v_subrev_u32 v13, 64, v13
    ds_write_b32 v26, v17 offset:32
    v_mfma_f32_16x16x32_bf16 v[40:43], v[128:131], v[152:155], v[40:43]
    ds_read_b128 v[176:179], v2 offset:0
    ds_read_b128 v[180:183], v2 offset:512
    v_mfma_f32_16x16x32_bf16 v[40:43], v[132:135], v[148:151], v[40:43]
    ds_read_b128 v[184:187], v2 offset:1024
    ds_read_b128 v[188:191], v2 offset:1536
    v_mfma_f32_16x16x32_bf16 v[40:43], v[136:139], v[144:147], v[40:43]
    ds_read_b128 v[80:83], v13 offset:0
    s_waitcnt lgkmcnt(12)
    v_mfma_f32_16x16x32_bf16 v[44:47], v[28:31], v[156:159], 0
    ds_read_b64_tr_b16 v[64:65], v12 offset:8
    v_mfma_f32_16x16x32_bf16 v[44:47], v[128:131], v[156:159], v[44:47]
    ds_read_b64_tr_b16 v[66:67], v12 offset:0
    v_mfma_f32_16x16x32_bf16 v[44:47], v[132:135], v[152:155], v[44:47]
    ds_read_b128 v[84:87], v13 offset:512
    v_mfma_f32_16x16x32_bf16 v[44:47], v[136:139], v[148:151], v[44:47]
    ds_read_b64_tr_b16 v[68:69], v12 offset:520
    v_mfma_f32_16x16x32_bf16 v[44:47], v[140:143], v[144:147], v[44:47]
    ds_read_b64_tr_b16 v[70:71], v12 offset:512
    s_waitcnt lgkmcnt(14)
    v_mfma_f32_16x16x32_bf16 v[48:51], v[28:31], v[160:163], 0
    ds_read_b128 v[88:91], v13 offset:1024
    v_mfma_f32_16x16x32_bf16 v[48:51], v[128:131], v[160:163], v[48:51]
    ds_read_b64_tr_b16 v[72:73], v12 offset:1032
    v_mfma_f32_16x16x32_bf16 v[48:51], v[132:135], v[156:159], v[48:51]
    ds_read_b64_tr_b16 v[74:75], v12 offset:1024
    v_mfma_f32_16x16x32_bf16 v[48:51], v[136:139], v[152:155], v[48:51]
    ds_read_b128 v[92:95], v13 offset:1536
    v_mfma_f32_16x16x32_bf16 v[48:51], v[140:143], v[148:151], v[48:51]
    ds_read_b64_tr_b16 v[76:77], v12 offset:1544
    v_mfma_f32_16x16x32_bf16 v[48:51], v[252:255], v[144:147], v[48:51]
    ds_read_b64_tr_b16 v[78:79], v12 offset:1536
    s_waitcnt lgkmcnt(15)
    v_mfma_f32_16x16x32_bf16 v[52:55], v[28:31], v[164:167], 0
    ds_read_b128 v[96:99], v13 offset:2048
    v_mfma_f32_16x16x32_bf16 v[52:55], v[128:131], v[164:167], v[52:55]
    ds_read_b128 v[100:103], v13 offset:2560
    v_mfma_f32_16x16x32_bf16 v[52:55], v[132:135], v[160:163], v[52:55]
    ds_read_b128 v[104:107], v13 offset:3072
    v_mfma_f32_16x16x32_bf16 v[52:55], v[136:139], v[156:159], v[52:55]
    ds_read_b128 v[108:111], v13 offset:3584
    v_mfma_f32_16x16x32_bf16 v[52:55], v[140:143], v[152:155], v[52:55]
    v_add_u32 v12, 64, v12
    v_mfma_f32_16x16x32_bf16 v[52:55], v[252:255], v[148:151], v[52:55]
    v_subrev_u32 v13, 64, v13
    s_waitcnt lgkmcnt(15)
    v_mfma_f32_16x16x32_bf16 v[56:59], v[28:31], v[168:171], 0
    v_mfma_f32_16x16x32_bf16 v[56:59], v[128:131], v[168:171], v[56:59]
    v_mfma_f32_16x16x32_bf16 v[56:59], v[132:135], v[164:167], v[56:59]
    v_mfma_f32_16x16x32_bf16 v[56:59], v[136:139], v[160:163], v[56:59]
    s_waitcnt vmcnt(0)
    s_mov_b32 exec_hi, 0
    buffer_store_dword v17, v23, s[84:87], s10 offen sc1
    s_mov_b64 exec, -1
    ds_write_b32 v26, v17 offset:48
    v_mfma_f32_16x16x32_bf16 v[56:59], v[140:143], v[156:159], v[56:59]
    v_mfma_f32_16x16x32_bf16 v[56:59], v[252:255], v[152:155], v[56:59]
    s_waitcnt lgkmcnt(15)
    v_mfma_f32_16x16x32_bf16 v[60:63], v[28:31], v[172:175], 0
    buffer_load_dwordx4 v[192:195], v4, s[68:71], s60 offen offset:0 sc1
    v_mfma_f32_16x16x32_bf16 v[60:63], v[128:131], v[172:175], v[60:63]
    v_mfma_f32_16x16x32_bf16 v[60:63], v[132:135], v[168:171], v[60:63]
    v_mfma_f32_16x16x32_bf16 v[60:63], v[136:139], v[164:167], v[60:63]
    buffer_load_dwordx4 v[196:199], v4, s[68:71], s60 offen offset:1024 sc1
    v_mfma_f32_16x16x32_bf16 v[60:63], v[140:143], v[160:163], v[60:63]
    v_mfma_f32_16x16x32_bf16 v[60:63], v[252:255], v[156:159], v[60:63]
    buffer_load_dwordx4 v[200:203], v4, s[68:71], s60 offen offset:2048 sc1
    s_waitcnt lgkmcnt(0)
    v_mfma_f32_16x16x32_bf16 v[32:35], v[64:67], v[80:83], v[32:35]
    v_mov_b32 v252, v8
    v_mov_b32 v253, v15
    v_mfma_f32_16x16x32_bf16 v[36:39], v[64:67], v[84:87], v[36:39]
    v_mov_b32 v254, v18
    v_mov_b32 v255, v22
    v_mfma_f32_16x16x32_bf16 v[36:39], v[68:71], v[80:83], v[36:39]
    ds_read_b128 v[144:147], v13 offset:0
    ds_read_b64_tr_b16 v[128:129], v12 offset:8
    v_mfma_f32_16x16x32_bf16 v[40:43], v[64:67], v[88:91], v[40:43]
    ds_read_b64_tr_b16 v[130:131], v12 offset:0
    v_mfma_f32_16x16x32_bf16 v[40:43], v[68:71], v[84:87], v[40:43]
    buffer_load_dwordx4 v[204:207], v4, s[68:71], s60 offen offset:3072 sc1
    ds_read_b128 v[148:151], v13 offset:512
    v_mfma_f32_16x16x32_bf16 v[40:43], v[72:75], v[80:83], v[40:43]
    ds_read_b64_tr_b16 v[132:133], v12 offset:520
    ds_read_b64_tr_b16 v[134:135], v12 offset:512
    v_mfma_f32_16x16x32_bf16 v[112:115], v[176:179], v[252:255], 0
    buffer_load_dwordx4 v[208:211], v9, s[68:71], s60 offen offset:0 sc1
    s_add_u32 s60, s60, 20480
    v_mfma_f32_16x16x32_bf16 v[116:119], v[180:183], v[252:255], 0
    ds_read_b128 v[152:155], v13 offset:1024
    ds_read_b64_tr_b16 v[136:137], v12 offset:1032
    v_mfma_f32_16x16x32_bf16 v[120:123], v[184:187], v[252:255], 0
    ds_read_b64_tr_b16 v[138:139], v12 offset:1024
    buffer_load_dwordx4 v[212:215], v4, s[68:71], s60 offen offset:0 sc1
    v_mfma_f32_16x16x32_bf16 v[124:127], v[188:191], v[252:255], 0
    ds_read_b128 v[156:159], v13 offset:1536
    v_mfma_f32_16x16x32_bf16 v[44:47], v[64:67], v[92:95], v[44:47]
    ds_read_b64_tr_b16 v[140:141], v12 offset:1544
    ds_read_b64_tr_b16 v[142:143], v12 offset:1536
    v_mfma_f32_16x16x32_bf16 v[44:47], v[68:71], v[88:91], v[44:47]
    buffer_load_dwordx4 v[216:219], v4, s[68:71], s60 offen offset:1024 sc1
    ds_read_b128 v[160:163], v13 offset:2048
    v_mfma_f32_16x16x32_bf16 v[44:47], v[72:75], v[84:87], v[44:47]
    ds_read_b128 v[164:167], v13 offset:2560
    v_mfma_f32_16x16x32_bf16 v[44:47], v[76:79], v[80:83], v[44:47]
    ds_read_b128 v[168:171], v13 offset:3072
    buffer_load_dwordx4 v[220:223], v4, s[68:71], s60 offen offset:2048 sc1
    v_mfma_f32_16x16x32_bf16 v[48:51], v[64:67], v[96:99], v[48:51]
    ds_read_b128 v[172:175], v13 offset:3584
    v_add_u32 v12, 64, v12
    v_mfma_f32_16x16x32_bf16 v[48:51], v[68:71], v[92:95], v[48:51]
    v_subrev_u32 v13, 64, v13
    v_mfma_f32_16x16x32_bf16 v[48:51], v[72:75], v[88:91], v[48:51]
    buffer_load_dwordx4 v[224:227], v4, s[68:71], s60 offen offset:3072 sc1
    v_cvt_pk_bf16_f32 v112, v112, v113
    v_mfma_f32_16x16x32_bf16 v[48:51], v[76:79], v[84:87], v[48:51]
    v_cvt_pk_bf16_f32 v113, v114, v115
    v_cvt_pk_bf16_f32 v114, v116, v117
    v_mfma_f32_16x16x32_bf16 v[52:55], v[64:67], v[100:103], v[52:55]
    v_cvt_pk_bf16_f32 v115, v118, v119
    v_mfma_f32_16x16x32_bf16 v[52:55], v[68:71], v[96:99], v[52:55]
    v_cvt_pk_bf16_f32 v116, v120, v121
    v_cvt_pk_bf16_f32 v117, v122, v123
    v_mfma_f32_16x16x32_bf16 v[52:55], v[72:75], v[92:95], v[52:55]
    v_cvt_pk_bf16_f32 v118, v124, v125
    v_cvt_pk_bf16_f32 v119, v126, v127
    v_mfma_f32_16x16x32_bf16 v[52:55], v[76:79], v[88:91], v[52:55]
    v_mov_b32 v184, 0
    v_mfma_f32_16x16x32_bf16 v[56:59], v[64:67], v[104:107], v[56:59]
    v_mov_b32 v185, 0
    ds_read_b64_tr_b16 v[182:183], v3 offset:0
    v_mfma_f32_16x16x32_bf16 v[56:59], v[68:71], v[100:103], v[56:59]
    ds_read_b64_tr_b16 v[180:181], v3 offset:32
    ds_read_b64_tr_b16 v[178:179], v3 offset:64
    v_mfma_f32_16x16x32_bf16 v[56:59], v[72:75], v[96:99], v[56:59]
    ds_read_b64_tr_b16 v[176:177], v3 offset:96
    v_mfma_f32_16x16x32_bf16 v[56:59], v[76:79], v[92:95], v[56:59]
    v_mfma_f32_16x16x32_bf16 v[60:63], v[64:67], v[108:111], v[60:63]
    v_mfma_f32_16x16x32_bf16 v[60:63], v[68:71], v[104:107], v[60:63]
    v_mfma_f32_16x16x32_bf16 v[60:63], v[72:75], v[100:103], v[60:63]
    v_mfma_f32_16x16x32_bf16 v[60:63], v[76:79], v[96:99], v[60:63]
    s_waitcnt lgkmcnt(0)
    v_mfma_f32_16x16x32_bf16 v[48:51], v[112:115], v[182:185], v[48:51]
    ds_read_b128 v[80:83], v13 offset:0
    v_mfma_f32_16x16x32_bf16 v[52:55], v[112:115], v[180:183], v[52:55]
    ds_read_b64_tr_b16 v[64:65], v12 offset:8
    v_mfma_f32_16x16x32_bf16 v[56:59], v[112:115], v[178:181], v[56:59]
    ds_read_b64_tr_b16 v[66:67], v12 offset:0
    v_mfma_f32_16x16x32_bf16 v[56:59], v[116:119], v[182:185], v[56:59]
    buffer_load_dwordx4 v[228:231], v9, s[68:71], s60 offen offset:0 sc1
    s_add_u32 s60, s60, 20480
    v_mfma_f32_16x16x32_bf16 v[60:63], v[112:115], v[176:179], v[60:63]
    ds_read_b128 v[84:87], v13 offset:512
    v_mfma_f32_16x16x32_bf16 v[60:63], v[116:119], v[180:183], v[60:63]
    ds_read_b64_tr_b16 v[68:69], v12 offset:520
    v_mfma_f32_16x16x32_bf16 v[32:35], v[128:131], v[144:147], v[32:35]
    ds_read_b64_tr_b16 v[70:71], v12 offset:512
    v_mfma_f32_16x16x32_bf16 v[36:39], v[128:131], v[148:151], v[36:39]
    buffer_load_dwordx4 v[232:235], v4, s[68:71], s60 offen offset:0 sc1
    v_mfma_f32_16x16x32_bf16 v[36:39], v[132:135], v[144:147], v[36:39]
    ds_read_b128 v[88:91], v13 offset:1024
    v_mfma_f32_16x16x32_bf16 v[40:43], v[128:131], v[152:155], v[40:43]
    ds_read_b64_tr_b16 v[72:73], v12 offset:1032
    v_mfma_f32_16x16x32_bf16 v[40:43], v[132:135], v[148:151], v[40:43]
    ds_read_b64_tr_b16 v[74:75], v12 offset:1024
    v_mfma_f32_16x16x32_bf16 v[40:43], v[136:139], v[144:147], v[40:43]
    buffer_load_dwordx4 v[236:239], v4, s[68:71], s60 offen offset:1024 sc1
    v_mfma_f32_16x16x32_bf16 v[44:47], v[128:131], v[156:159], v[44:47]
    ds_read_b128 v[92:95], v13 offset:1536
    v_mfma_f32_16x16x32_bf16 v[44:47], v[132:135], v[152:155], v[44:47]
    v_mfma_f32_16x16x32_bf16 v[44:47], v[136:139], v[148:151], v[44:47]
    ds_read_b64_tr_b16 v[76:77], v12 offset:1544
    v_mfma_f32_16x16x32_bf16 v[44:47], v[140:143], v[144:147], v[44:47]
    ds_read_b64_tr_b16 v[78:79], v12 offset:1536
    v_mfma_f32_16x16x32_bf16 v[48:51], v[128:131], v[160:163], v[48:51]
    buffer_load_dwordx4 v[240:243], v4, s[68:71], s60 offen offset:2048 sc1
    v_mfma_f32_16x16x32_bf16 v[48:51], v[132:135], v[156:159], v[48:51]
    ds_read_b128 v[96:99], v13 offset:2048
    v_mfma_f32_16x16x32_bf16 v[48:51], v[136:139], v[152:155], v[48:51]
    ds_read_b128 v[100:103], v13 offset:2560
    v_mfma_f32_16x16x32_bf16 v[48:51], v[140:143], v[148:151], v[48:51]
    ds_read_b128 v[104:107], v13 offset:3072
    v_mfma_f32_16x16x32_bf16 v[52:55], v[128:131], v[164:167], v[52:55]
    buffer_load_dwordx4 v[244:247], v4, s[68:71], s60 offen offset:3072 sc1
    v_mfma_f32_16x16x32_bf16 v[52:55], v[132:135], v[160:163], v[52:55]
    ds_read_b128 v[108:111], v13 offset:3584
    v_mfma_f32_16x16x32_bf16 v[52:55], v[136:139], v[156:159], v[52:55]
    v_add_u32 v12, 64, v12
    v_mfma_f32_16x16x32_bf16 v[52:55], v[140:143], v[152:155], v[52:55]
    v_subrev_u32 v13, 64, v13
    v_mfma_f32_16x16x32_bf16 v[56:59], v[128:131], v[168:171], v[56:59]
    buffer_load_dwordx4 v[248:251], v9, s[68:71], s60 offen offset:0 sc1
    s_add_u32 s60, s60, 20480
    v_mfma_f32_16x16x32_bf16 v[56:59], v[132:135], v[164:167], v[56:59]
    ds_read_b32 v21, v20 offset:16
    v_mfma_f32_16x16x32_bf16 v[56:59], v[136:139], v[160:163], v[56:59]
    v_mfma_f32_16x16x32_bf16 v[56:59], v[140:143], v[156:159], v[56:59]
    v_mfma_f32_16x16x32_bf16 v[60:63], v[128:131], v[172:175], v[60:63]
    v_mfma_f32_16x16x32_bf16 v[60:63], v[132:135], v[168:171], v[60:63]
    v_mfma_f32_16x16x32_bf16 v[60:63], v[136:139], v[164:167], v[60:63]
    v_mfma_f32_16x16x32_bf16 v[60:63], v[140:143], v[160:163], v[60:63]
    s_waitcnt lgkmcnt(0)
L_cp_3:
    v_cmp_ne_u32 vcc, s95, v21
    s_cmp_eq_u64 vcc, 0
    s_cbranch_scc1 L_cp_4
    s_add_u32 s89, s89, 1
    s_cmp_ge_u32 s89, 400000
    s_cbranch_scc1 L_cp_4
    s_sleep 1
    ds_read_b32 v21, v20 offset:16
    s_waitcnt lgkmcnt(0)
    s_branch L_cp_3
L_cp_4:
L_cvx:
    s_cmp_eq_u32 s78, 1
    s_cbranch_scc1 L_cx1
    v_mfma_f32_16x16x32_bf16 v[60:63], v[64:67], v[108:111], v[60:63]
    v_mfma_f32_16x16x32_bf16 v[60:63], v[68:71], v[104:107], v[60:63]
    v_mfma_f32_16x16x32_bf16 v[60:63], v[72:75], v[100:103], v[60:63]
    v_mfma_f32_16x16x32_bf16 v[60:63], v[76:79], v[96:99], v[60:63]
    v_mfma_f32_16x16x32_bf16 v[56:59], v[64:67], v[104:107], v[56:59]
    v_mfma_f32_16x16x32_bf16 v[56:59], v[68:71], v[100:103], v[56:59]
    v_mfma_f32_16x16x32_bf16 v[56:59], v[72:75], v[96:99], v[56:59]
    v_mfma_f32_16x16x32_bf16 v[56:59], v[76:79], v[92:95], v[56:59]
    v_mfma_f32_16x16x32_bf16 v[52:55], v[64:67], v[100:103], v[52:55]
    v_mfma_f32_16x16x32_bf16 v[52:55], v[68:71], v[96:99], v[52:55]
    v_mfma_f32_16x16x32_bf16 v[52:55], v[72:75], v[92:95], v[52:55]
    v_mfma_f32_16x16x32_bf16 v[52:55], v[76:79], v[88:91], v[52:55]
    v_mfma_f32_16x16x32_bf16 v[48:51], v[64:67], v[96:99], v[48:51]
    v_mfma_f32_16x16x32_bf16 v[48:51], v[68:71], v[92:95], v[48:51]
    v_mfma_f32_16x16x32_bf16 v[48:51], v[72:75], v[88:91], v[48:51]
    v_mfma_f32_16x16x32_bf16 v[48:51], v[76:79], v[84:87], v[48:51]
    v_mfma_f32_16x16x32_bf16 v[44:47], v[64:67], v[92:95], v[44:47]
    v_mfma_f32_16x16x32_bf16 v[44:47], v[68:71], v[88:91], v[44:47]
    v_mfma_f32_16x16x32_bf16 v[44:47], v[72:75], v[84:87], v[44:47]
    v_mfma_f32_16x16x32_bf16 v[44:47], v[76:79], v[80:83], v[44:47]
    v_mfma_f32_16x16x32_bf16 v[40:43], v[64:67], v[88:91], v[40:43]
    ds_write_b128 v24, v[60:63] offset:3072
    v_mfma_f32_16x16x32_bf16 v[40:43], v[68:71], v[84:87], v[40:43]
    ds_write_b128 v24, v[56:59] offset:2048
    v_mfma_f32_16x16x32_bf16 v[40:43], v[72:75], v[80:83], v[40:43]
    ds_write_b128 v24, v[52:55] offset:1024
    v_mfma_f32_16x16x32_bf16 v[36:39], v[64:67], v[84:87], v[36:39]
    ds_write_b128 v24, v[48:51] offset:0
    v_mfma_f32_16x16x32_bf16 v[36:39], v[68:71], v[80:83], v[36:39]
    ds_write_b32 v26, v17
    v_mfma_f32_16x16x32_bf16 v[32:35], v[64:67], v[80:83], v[32:35]
    ds_read_b32 v21, v27
    s_waitcnt lgkmcnt(0)
L_cs_5:
    v_cmp_ne_u32 vcc, s95, v21
    s_cmp_eq_u64 vcc, 0
    s_cbranch_scc1 L_cs_6
    s_add_u32 s89, s89, 1
    s_cmp_ge_u32 s89, 400000
    s_cbranch_scc1 L_cs_6
    ds_read_b32 v21, v27
    s_waitcnt lgkmcnt(0)
    s_branch L_cs_5
L_cs_6:
    ds_read_b128 v[128:131], v25 offset:0
    ds_read_b128 v[132:135], v25 offset:1024
    ds_read_b128 v[136:139], v25 offset:2048
    ds_read_b128 v[140:143], v25 offset:3072
    s_waitcnt lgkmcnt(3)
    v_add_f32 v32, v32, v128
    v_add_f32 v33, v33, v129
    v_add_f32 v34, v34, v130
    v_add_f32 v35, v35, v131
    s_waitcnt lgkmcnt(2)
    v_add_f32 v36, v36, v132
    v_add_f32 v37, v37, v133
    v_add_f32 v38, v38, v134
    v_add_f32 v39, v39, v135
    s_waitcnt lgkmcnt(1)
    v_add_f32 v40, v40, v136
    v_add_f32 v41, v41, v137
    v_add_f32 v42, v42, v138
    v_add_f32 v43, v43, v139
    s_waitcnt lgkmcnt(0)
    v_add_f32 v44, v44, v140
    v_add_f32 v45, v45, v141
    v_add_f32 v46, v46, v142
    v_add_f32 v47, v47, v143
    v_cvt_pk_bf16_f32 v160, v32, v33
    v_cvt_pk_bf16_f32 v161, v34, v35
    v_cvt_pk_bf16_f32 v162, v36, v37
    v_cvt_pk_bf16_f32 v163, v38, v39
    v_cvt_pk_bf16_f32 v164, v40, v41
    v_cvt_pk_bf16_f32 v165, v42, v43
    v_cvt_pk_bf16_f32 v166, v44, v45
    v_cvt_pk_bf16_f32 v167, v46, v47
    s_nop 0
    v_permlane16_swap_b32 v160, v162
    v_permlane16_swap_b32 v161, v163
    buffer_store_dwordx4 v[160:163], v16, s[52:55], s79 offen offset:0 sc1
    v_permlane16_swap_b32 v164, v166
    v_permlane16_swap_b32 v165, v167
    buffer_store_dwordx4 v[164:167], v16, s[52:55], s79 offen offset:1024 sc1
    s_branch L_cpub
L_cx1:
    v_mfma_f32_16x16x32_bf16 v[44:47], v[64:67], v[92:95], v[44:47]
    v_mfma_f32_16x16x32_bf16 v[44:47], v[68:71], v[88:91], v[44:47]
    v_mfma_f32_16x16x32_bf16 v[44:47], v[72:75], v[84:87], v[44:47]
    v_mfma_f32_16x16x32_bf16 v[44:47], v[76:79], v[80:83], v[44:47]
    v_mfma_f32_16x16x32_bf16 v[40:43], v[64:67], v[88:91], v[40:43]
    v_mfma_f32_16x16x32_bf16 v[40:43], v[68:71], v[84:87], v[40:43]
    v_mfma_f32_16x16x32_bf16 v[40:43], v[72:75], v[80:83], v[40:43]
    v_mfma_f32_16x16x32_bf16 v[36:39], v[64:67], v[84:87], v[36:39]
    v_mfma_f32_16x16x32_bf16 v[36:39], v[68:71], v[80:83], v[36:39]
    v_mfma_f32_16x16x32_bf16 v[32:35], v[64:67], v[80:83], v[32:35]
    v_mfma_f32_16x16x32_bf16 v[60:63], v[64:67], v[108:111], v[60:63]
    v_mfma_f32_16x16x32_bf16 v[60:63], v[68:71], v[104:107], v[60:63]
    v_mfma_f32_16x16x32_bf16 v[60:63], v[72:75], v[100:103], v[60:63]
    v_mfma_f32_16x16x32_bf16 v[60:63], v[76:79], v[96:99], v[60:63]
    v_mfma_f32_16x16x32_bf16 v[56:59], v[64:67], v[104:107], v[56:59]
    ds_write_b128 v24, v[44:47] offset:3072
    v_mfma_f32_16x16x32_bf16 v[56:59], v[68:71], v[100:103], v[56:59]
    ds_write_b128 v24, v[40:43] offset:2048
    v_mfma_f32_16x16x32_bf16 v[56:59], v[72:75], v[96:99], v[56:59]
    ds_write_b128 v24, v[36:39] offset:1024
    v_mfma_f32_16x16x32_bf16 v[56:59], v[76:79], v[92:95], v[56:59]
    ds_write_b128 v24, v[32:35] offset:0
    v_mfma_f32_16x16x32_bf16 v[52:55], v[64:67], v[100:103], v[52:55]
    ds_write_b32 v26, v17
    v_mfma_f32_16x16x32_bf16 v[52:55], v[68:71], v[96:99], v[52:55]
    v_mfma_f32_16x16x32_bf16 v[52:55], v[72:75], v[92:95], v[52:55]
    v_mfma_f32_16x16x32_bf16 v[52:55], v[76:79], v[88:91], v[52:55]
    v_mfma_f32_16x16x32_bf16 v[48:51], v[64:67], v[96:99], v[48:51]
    v_mfma_f32_16x16x32_bf16 v[48:51], v[68:71], v[92:95], v[48:51]
    v_mfma_f32_16x16x32_bf16 v[48:51], v[72:75], v[88:91], v[48:51]
    v_mfma_f32_16x16x32_bf16 v[48:51], v[76:79], v[84:87], v[48:51]
    ds_read_b32 v21, v27
    s_waitcnt lgkmcnt(0)
L_cs_7:
    v_cmp_ne_u32 vcc, s95, v21
    s_cmp_eq_u64 vcc, 0
    s_cbranch_scc1 L_cs_8
    s_add_u32 s89, s89, 1
    s_cmp_ge_u32 s89, 400000
    s_cbranch_scc1 L_cs_8
    ds_read_b32 v21, v27
    s_waitcnt lgkmcnt(0)
    s_branch L_cs_7
L_cs_8:
    ds_read_b128 v[128:131], v25 offset:0
    ds_read_b128 v[132:135], v25 offset:1024
    ds_read_b128 v[136:139], v25 offset:2048
    ds_read_b128 v[140:143], v25 offset:3072
    s_waitcnt lgkmcnt(3)
    v_add_f32 v48, v48, v128
    v_add_f32 v49, v49, v129
    v_add_f32 v50, v50, v130
    v_add_f32 v51, v51, v131
    s_waitcnt lgkmcnt(2)
    v_add_f32 v52, v52, v132
    v_add_f32 v53, v53, v133
    v_add_f32 v54, v54, v134
    v_add_f32 v55, v55, v135
    s_waitcnt lgkmcnt(1)
    v_add_f32 v56, v56, v136
    v_add_f32 v57, v57, v137
    v_add_f32 v58, v58, v138
    v_add_f32 v59, v59, v139
    s_waitcnt lgkmcnt(0)
    v_add_f32 v60, v60, v140
    v_add_f32 v61, v61, v141
    v_add_f32 v62, v62, v142
    v_add_f32 v63, v63, v143
    v_cvt_pk_bf16_f32 v160, v48, v49
    v_cvt_pk_bf16_f32 v161, v50, v51
    v_cvt_pk_bf16_f32 v162, v52, v53
    v_cvt_pk_bf16_f32 v163, v54, v55
    v_cvt_pk_bf16_f32 v164, v56, v57
    v_cvt_pk_bf16_f32 v165, v58, v59
    v_cvt_pk_bf16_f32 v166, v60, v61
    v_cvt_pk_bf16_f32 v167, v62, v63
    s_nop 0
    v_permlane16_swap_b32 v160, v162
    v_permlane16_swap_b32 v161, v163
    buffer_store_dwordx4 v[160:163], v16, s[52:55], s79 offen offset:0 sc1
    v_permlane16_swap_b32 v164, v166
    v_permlane16_swap_b32 v165, v167
    buffer_store_dwordx4 v[164:167], v16, s[52:55], s79 offen offset:1024 sc1
L_cpub:
    s_waitcnt vmcnt(0)
    s_mov_b64 exec, 1
    buffer_store_dword v17, off, s[84:87], s61 sc1
    s_mov_b64 exec, -1
L_carry:
    s_setprio 0
    ds_read_b32 v21, v26 offset:96
    s_waitcnt lgkmcnt(0)
L_fr_9:
    v_cmp_ne_u32 vcc, s95, v21
    s_cmp_eq_u64 vcc, 0
    s_cbranch_scc1 L_fr_10
    s_add_u32 s89, s89, 1
    s_cmp_ge_u32 s89, 400000
    s_cbranch_scc1 L_fr_10
    s_sleep 2
    ds_read_b32 v21, v26 offset:96
    s_waitcnt lgkmcnt(0)
    s_branch L_fr_9
L_fr_10:
    ds_write_b128 v14, v[192:195] offset:0
    ds_write_b128 v14, v[196:199] offset:1024
    ds_write_b128 v14, v[200:203] offset:2048
    ds_write_b128 v14, v[204:207] offset:3072
    ds_write_b128 v14, v[208:211] offset:4096
    ds_write_b128 v14, v[212:215] offset:20480
    ds_write_b128 v14, v[216:219] offset:21504
    ds_write_b128 v14, v[220:223] offset:22528
    ds_write_b128 v14, v[224:227] offset:23552
    ds_write_b128 v14, v[228:231] offset:24576
    ds_write_b128 v14, v[232:235] offset:40960
    ds_write_b128 v14, v[236:239] offset:41984
    ds_write_b128 v14, v[240:243] offset:43008
    ds_write_b128 v14, v[244:247] offset:44032
    ds_write_b128 v14, v[248:251] offset:45056
    ds_write_b32 v26, v17 offset:112
    s_branch L_done
L_conv:
    v_and_b32 v6, 15, v0
    v_lshrrev_b32 v7, 4, v0
    v_lshlrev_b32 v4, 4, v0
    v_and_b32 v5, 3, v0
    v_bfe_u32 v3, v0, 2, 2
    v_sub_u32 v12, 4, v3
    v_and_b32 v12, 3, v12
    v_mul_u32_u24 v12, 2624, v12
    v_lshl_add_u32 v12, v5, 3, v12
    v_min_u32 v13, 1, v3
    v_lshl_add_u32 v13, v7, 1, v13
    v_lshlrev_b32 v13, 3, v13
    s_lshl_b32 s76, s78, 8
    s_add_u32 s77, s73, s76
    s_sub_u32 s76, s73, s76
    s_add_u32 s77, s77, 56
    s_add_u32 s76, s76, 10976
    v_sub_u32 v12, v12, v13
    v_add_u32 v12, s77, v12
    v_lshlrev_b32 v16, 5, v6
    v_lshl_add_u32 v13, v7, 4, v16
    v_add_u32 v13, s76, v13
    v_lshlrev_b32 v22, 3, v7
    v_sub_u32 v22, v6, v22
    s_lshl_b32 s76, s78, 6
    s_add_u32 s76, s76, 16
    v_add_u32 v22, s76, v22
    v_and_b32 v15, 1, v22
    v_xor_b32 v15, 1, v15
    v_lshlrev_b32 v15, 4, v15
    v_lshrrev_b32 v22, 1, v22
    v_cmp_eq_u32 s[44:45], 0, v22
    v_cmp_eq_u32 s[46:47], 1, v22
    v_cmp_eq_u32 s[48:49], 2, v22
    v_cmp_eq_u32 s[50:51], 3, v22
    v_lshrrev_b32 v17, 1, v7
    v_lshl_add_u32 v16, v17, 4, v16
    v_and_b32 v17, 1, v7
    v_lshl_add_u32 v16, v17, 9, v16
    s_mul_i32 s79, s72, 4224
    s_lshl_b32 s76, s78, 11
    s_add_u32 s79, s79, s76
    s_mul_i32 s61, s72, 3277
    s_lshr_b32 s61, s61, 16
    s_mul_i32 s61, s61, 48
    s_lshl2_add_u32 s61, s72, s61
    s_add_u32 s61, s61, 158720
    s_lshl1_add_u32 s61, s76, s61
    s_lshl_b32 s76, s3, 12
    s_add_u32 s76, s76, 147456
    v_add_u32 v24, s76, v4
    v_xor_b32 v25, 8192, v24
    s_lshl2_add_u32 s76, s3, 42496
    v_mov_b32 v26, s76
    v_xor_b32 v27, 8, v26
    s_mul_i32 s76, s3, 5120
    s_add_u32 s76, s76, 43008
    v_add_u32 v14, s76, v4
    v_lshlrev_b32 v20, 2, v5
    v_add_u32 v20, 42512, v20
    v_lshlrev_b32 v23, 2, v0
    s_mov_b32 s62, s78
    s_lshl_b32 s76, s78, 8
    s_lshl_b32 s77, s62, 4
    s_sub_u32 s77, s76, s77
    v_add_u32 v2, s77, v13
    s_mul_i32 s77, s62, 160
    s_sub_u32 s77, s77, s76
    s_add_u32 s77, s77, 2216
    v_lshl_add_u32 v3, v7, 3, v12
    v_add_u32 v3, s77, v3
    s_mul_i32 s77, s78, 192
    v_subrev_u32 v10, s77, v12
    ds_read_b64_tr_b16 v[252:253], v10 offset:2056
    ds_read_b64_tr_b16 v[254:255], v10 offset:2048
    ds_read_b128 v[144:147], v13 offset:0
    ds_read_b64_tr_b16 v[128:129], v12 offset:8
    ds_read_b64_tr_b16 v[130:131], v12 offset:0
    ds_read_b128 v[148:151], v13 offset:512
    ds_read_b64_tr_b16 v[132:133], v12 offset:520
    ds_read_b64_tr_b16 v[134:135], v12 offset:512
    ds_read_b128 v[152:155], v13 offset:1024
    ds_read_b64_tr_b16 v[136:137], v12 offset:1032
    ds_read_b64_tr_b16 v[138:139], v12 offset:1024
    ds_read_b128 v[156:159], v13 offset:1536
    ds_read_b64_tr_b16 v[140:141], v12 offset:1544
    ds_read_b64_tr_b16 v[142:143], v12 offset:1536
    ds_read_b128 v[160:163], v13 offset:2048
    ds_read_b128 v[164:167], v13 offset:2560
    ds_read_b128 v[168:171], v13 offset:3072
    ds_read_b128 v[172:175], v13 offset:3584
    v_add_u32 v12, 64, v12
    v_subrev_u32 v13, 64, v13
    v_lshrrev_b32 v15, v15, v18
    v_cndmask_b32 v28, 0, v15, s[44:45]
    v_cndmask_b32 v29, 0, v15, s[46:47]
    v_cndmask_b32 v30, 0, v15, s[48:49]
    v_cndmask_b32 v31, 0, v15, s[50:51]
    v_mov_b32 v17, s95
    s_waitcnt lgkmcnt(0)
    v_mfma_f32_16x16x32_bf16 v[32:35], v[28:31], v[144:147], 0
    v_mfma_f32_16x16x32_bf16 v[36:39], v[28:31], v[148:151], 0
    v_mfma_f32_16x16x32_bf16 v[40:43], v[28:31], v[152:155], 0
    v_mfma_f32_16x16x32_bf16 v[44:47], v[28:31], v[156:159], 0
    v_mfma_f32_16x16x32_bf16 v[48:51], v[28:31], v[160:163], 0
    v_mfma_f32_16x16x32_bf16 v[52:55], v[28:31], v[164:167], 0
    v_mfma_f32_16x16x32_bf16 v[56:59], v[28:31], v[168:171], 0
    v_mfma_f32_16x16x32_bf16 v[60:63], v[28:31], v[172:175], 0
    v_mfma_f32_16x16x32_bf16 v[48:51], v[252:255], v[144:147], v[48:51]
    v_mfma_f32_16x16x32_bf16 v[52:55], v[252:255], v[148:151], v[52:55]
    v_mfma_f32_16x16x32_bf16 v[56:59], v[252:255], v[152:155], v[56:59]
    v_mfma_f32_16x16x32_bf16 v[60:63], v[252:255], v[156:159], v[60:63]
L_hy:
    ds_read_b128 v[176:179], v2 offset:0
    ds_read_b128 v[180:183], v2 offset:512
    ds_read_b128 v[184:187], v2 offset:1024
    ds_read_b128 v[188:191], v2 offset:1536
    s_lshl_b32 s76, s62, 1
    s_lshl_b32 s76, 128, s76
    s_sub_u32 s76, s76, 1
    s_sub_u32 s77, 5, s62
    v_add_u32 v20, s77, v6
    v_lshlrev_b32_e64 v20, v20, s76
    v_lshlrev_b32 v21, 3, v7
    v_lshrrev_b32 v20, v21, v20
    v_bfe_u32 v252, v20, 0, 1
    v_bfe_u32 v21, v20, 1, 1
    v_lshl_or_b32 v252, v21, 16, v252
    v_mul_u32_u24 v252, 0x3f80, v252
    v_bfe_u32 v253, v20, 2, 1
    v_bfe_u32 v21, v20, 3, 1
    v_lshl_or_b32 v253, v21, 16, v253
    v_mul_u32_u24 v253, 0x3f80, v253
    v_bfe_u32 v254, v20, 4, 1
    v_bfe_u32 v21, v20, 5, 1
    v_lshl_or_b32 v254, v21, 16, v254
    v_mul_u32_u24 v254, 0x3f80, v254
    v_bfe_u32 v255, v20, 6, 1
    v_bfe_u32 v21, v20, 7, 1
    v_lshl_or_b32 v255, v21, 16, v255
    v_mul_u32_u24 v255, 0x3f80, v255
    s_waitcnt lgkmcnt(0)
    s_nop 0
    v_mfma_f32_16x16x32_bf16 v[112:115], v[176:179], v[252:255], 0
    v_mfma_f32_16x16x32_bf16 v[116:119], v[180:183], v[252:255], 0
    v_mfma_f32_16x16x32_bf16 v[120:123], v[184:187], v[252:255], 0
    v_mfma_f32_16x16x32_bf16 v[124:127], v[188:191], v[252:255], 0
    s_nop 4
    v_cvt_pk_bf16_f32 v112, v112, v113
    v_cvt_pk_bf16_f32 v113, v114, v115
    v_cvt_pk_bf16_f32 v114, v116, v117
    v_cvt_pk_bf16_f32 v115, v118, v119
    v_cvt_pk_bf16_f32 v116, v120, v121
    v_cvt_pk_bf16_f32 v117, v122, v123
    v_cvt_pk_bf16_f32 v118, v124, v125
    v_cvt_pk_bf16_f32 v119, v126, v127
    v_mov_b32 v184, 0
    v_mov_b32 v185, 0
    ds_read_b64_tr_b16 v[182:183], v3 offset:0
    ds_read_b64_tr_b16 v[180:181], v3 offset:32
    ds_read_b64_tr_b16 v[178:179], v3 offset:64
    ds_read_b64_tr_b16 v[176:177], v3 offset:96
    s_waitcnt lgkmcnt(0)
    v_mfma_f32_16x16x32_bf16 v[48:51], v[112:115], v[182:185], v[48:51]
    v_mfma_f32_16x16x32_bf16 v[52:55], v[112:115], v[180:183], v[52:55]
    v_mfma_f32_16x16x32_bf16 v[56:59], v[112:115], v[178:181], v[56:59]
    v_mfma_f32_16x16x32_bf16 v[56:59], v[116:119], v[182:185], v[56:59]
    v_mfma_f32_16x16x32_bf16 v[60:63], v[112:115], v[176:179], v[60:63]
    v_mfma_f32_16x16x32_bf16 v[60:63], v[116:119], v[180:183], v[60:63]
    s_lshl1_add_u32 s77, s62, s83
    s_cmp_lg_u32 s77, 1
    s_cbranch_scc1 L_hyd
    s_mov_b32 s62, 1
    v_subrev_u32 v2, 16, v2
    v_add_u32 v3, 160, v3
    s_branch L_hy
L_hyd:
    s_and_b32 s76, s83, 2
L_cv2:
    s_waitcnt lgkmcnt(0)
    v_mfma_f32_16x16x32_bf16 v[32:35], v[128:131], v[144:147], v[32:35]
    ds_read_b128 v[80:83], v13 offset:0
    ds_read_b64_tr_b16 v[64:65], v12 offset:8
    v_mfma_f32_16x16x32_bf16 v[36:39], v[128:131], v[148:151], v[36:39]
    ds_read_b64_tr_b16 v[66:67], v12 offset:0
    v_mfma_f32_16x16x32_bf16 v[36:39], v[132:135], v[144:147], v[36:39]
    ds_read_b128 v[84:87], v13 offset:512
    v_mfma_f32_16x16x32_bf16 v[40:43], v[128:131], v[152:155], v[40:43]
    ds_read_b64_tr_b16 v[68:69], v12 offset:520
    v_mfma_f32_16x16x32_bf16 v[40:43], v[132:135], v[148:151], v[40:43]
    ds_read_b64_tr_b16 v[70:71], v12 offset:512
    v_mfma_f32_16x16x32_bf16 v[40:43], v[136:139], v[144:147], v[40:43]
    ds_read_b128 v[88:91], v13 offset:1024
    v_mfma_f32_16x16x32_bf16 v[44:47], v[128:131], v[156:159], v[44:47]
    ds_read_b64_tr_b16 v[72:73], v12 offset:1032
    v_mfma_f32_16x16x32_bf16 v[44:47], v[132:135], v[152:155], v[44:47]
    ds_read_b64_tr_b16 v[74:75], v12 offset:1024
    v_mfma_f32_16x16x32_bf16 v[44:47], v[136:139], v[148:151], v[44:47]
    ds_read_b128 v[92:95], v13 offset:1536
    v_mfma_f32_16x16x32_bf16 v[44:47], v[140:143], v[144:147], v[44:47]
    ds_read_b64_tr_b16 v[76:77], v12 offset:1544
    v_mfma_f32_16x16x32_bf16 v[48:51], v[128:131], v[160:163], v[48:51]
    ds_read_b64_tr_b16 v[78:79], v12 offset:1536
    v_mfma_f32_16x16x32_bf16 v[48:51], v[132:135], v[156:159], v[48:51]
    ds_read_b128 v[96:99], v13 offset:2048
    v_mfma_f32_16x16x32_bf16 v[48:51], v[136:139], v[152:155], v[48:51]
    ds_read_b128 v[100:103], v13 offset:2560
    v_mfma_f32_16x16x32_bf16 v[48:51], v[140:143], v[148:151], v[48:51]
    ds_read_b128 v[104:107], v13 offset:3072
    v_mfma_f32_16x16x32_bf16 v[52:55], v[128:131], v[164:167], v[52:55]
    ds_read_b128 v[108:111], v13 offset:3584
    v_mfma_f32_16x16x32_bf16 v[52:55], v[132:135], v[160:163], v[52:55]
    v_add_u32 v12, 64, v12
    v_mfma_f32_16x16x32_bf16 v[52:55], v[136:139], v[156:159], v[52:55]
    v_subrev_u32 v13, 64, v13
    v_mfma_f32_16x16x32_bf16 v[52:55], v[140:143], v[152:155], v[52:55]
    s_add_u32 s76, s76, 1
    v_mfma_f32_16x16x32_bf16 v[56:59], v[128:131], v[168:171], v[56:59]
    s_lshl2_add_u32 s77, s83, s76
    v_mfma_f32_16x16x32_bf16 v[56:59], v[132:135], v[164:167], v[56:59]
    s_cmp_eq_u32 s77, 12
    v_mfma_f32_16x16x32_bf16 v[56:59], v[136:139], v[160:163], v[56:59]
    v_mfma_f32_16x16x32_bf16 v[56:59], v[140:143], v[156:159], v[56:59]
    v_mfma_f32_16x16x32_bf16 v[60:63], v[128:131], v[172:175], v[60:63]
    v_mfma_f32_16x16x32_bf16 v[60:63], v[132:135], v[168:171], v[60:63]
    v_mfma_f32_16x16x32_bf16 v[60:63], v[136:139], v[164:167], v[60:63]
    v_mfma_f32_16x16x32_bf16 v[60:63], v[140:143], v[160:163], v[60:63]
    s_waitcnt lgkmcnt(0)
    s_cbranch_scc1 L_cvx
    s_cmp_lg_u32 s83, 2
    s_cbranch_scc1 L_cvn1
    s_waitcnt vmcnt(0)
    s_add_u32 s13, s63, 4096
    s_mov_b64 exec, 1
    buffer_store_dword v17, off, s[84:87], s63 sc1
    buffer_store_dword v17, off, s[84:87], s13 sc1
    s_mov_b64 exec, -1
L_cvn1:
    v_mfma_f32_16x16x32_bf16 v[32:35], v[64:67], v[80:83], v[32:35]
    ds_read_b128 v[144:147], v13 offset:0
    v_mfma_f32_16x16x32_bf16 v[36:39], v[64:67], v[84:87], v[36:39]
    ds_read_b64_tr_b16 v[128:129], v12 offset:8
    v_mfma_f32_16x16x32_bf16 v[36:39], v[68:71], v[80:83], v[36:39]
    ds_read_b64_tr_b16 v[130:131], v12 offset:0
    v_mfma_f32_16x16x32_bf16 v[40:43], v[64:67], v[88:91], v[40:43]
    ds_read_b128 v[148:151], v13 offset:512
    v_mfma_f32_16x16x32_bf16 v[40:43], v[68:71], v[84:87], v[40:43]
    ds_read_b64_tr_b16 v[132:133], v12 offset:520
    v_mfma_f32_16x16x32_bf16 v[40:43], v[72:75], v[80:83], v[40:43]
    ds_read_b64_tr_b16 v[134:135], v12 offset:512
    v_mfma_f32_16x16x32_bf16 v[44:47], v[64:67], v[92:95], v[44:47]
    ds_read_b128 v[152:155], v13 offset:1024
    v_mfma_f32_16x16x32_bf16 v[44:47], v[68:71], v[88:91], v[44:47]
    ds_read_b64_tr_b16 v[136:137], v12 offset:1032
    v_mfma_f32_16x16x32_bf16 v[44:47], v[72:75], v[84:87], v[44:47]
    ds_read_b64_tr_b16 v[138:139], v12 offset:1024
    v_mfma_f32_16x16x32_bf16 v[44:47], v[76:79], v[80:83], v[44:47]
    ds_read_b128 v[156:159], v13 offset:1536
    v_mfma_f32_16x16x32_bf16 v[48:51], v[64:67], v[96:99], v[48:51]
    ds_read_b64_tr_b16 v[140:141], v12 offset:1544
    v_mfma_f32_16x16x32_bf16 v[48:51], v[68:71], v[92:95], v[48:51]
    ds_read_b64_tr_b16 v[142:143], v12 offset:1536
    v_mfma_f32_16x16x32_bf16 v[48:51], v[72:75], v[88:91], v[48:51]
    ds_read_b128 v[160:163], v13 offset:2048
    v_mfma_f32_16x16x32_bf16 v[48:51], v[76:79], v[84:87], v[48:51]
    ds_read_b128 v[164:167], v13 offset:2560
    v_mfma_f32_16x16x32_bf16 v[52:55], v[64:67], v[100:103], v[52:55]
    ds_read_b128 v[168:171], v13 offset:3072
    v_mfma_f32_16x16x32_bf16 v[52:55], v[68:71], v[96:99], v[52:55]
    ds_read_b128 v[172:175], v13 offset:3584
    v_mfma_f32_16x16x32_bf16 v[52:55], v[72:75], v[92:95], v[52:55]
    v_add_u32 v12, 64, v12
    v_mfma_f32_16x16x32_bf16 v[52:55], v[76:79], v[88:91], v[52:55]
    v_subrev_u32 v13, 64, v13
    v_mfma_f32_16x16x32_bf16 v[56:59], v[64:67], v[104:107], v[56:59]
    s_cmp_lt_u32 s76, 4
    v_mfma_f32_16x16x32_bf16 v[56:59], v[68:71], v[100:103], v[56:59]
    v_mfma_f32_16x16x32_bf16 v[56:59], v[72:75], v[96:99], v[56:59]
    v_mfma_f32_16x16x32_bf16 v[56:59], v[76:79], v[92:95], v[56:59]
    v_mfma_f32_16x16x32_bf16 v[60:63], v[64:67], v[108:111], v[60:63]
    v_mfma_f32_16x16x32_bf16 v[60:63], v[68:71], v[104:107], v[60:63]
    v_mfma_f32_16x16x32_bf16 v[60:63], v[72:75], v[100:103], v[60:63]
    v_mfma_f32_16x16x32_bf16 v[60:63], v[76:79], v[96:99], v[60:63]
    s_cbranch_scc1 L_cv2
    s_waitcnt lgkmcnt(0)
    s_barrier
    s_nop 4
    v_cvt_pk_bf16_f32 v160, v32, v33
    v_cvt_pk_bf16_f32 v161, v34, v35
    v_cvt_pk_bf16_f32 v162, v36, v37
    v_cvt_pk_bf16_f32 v163, v38, v39
    v_cvt_pk_bf16_f32 v164, v40, v41
    v_cvt_pk_bf16_f32 v165, v42, v43
    v_cvt_pk_bf16_f32 v166, v44, v45
    v_cvt_pk_bf16_f32 v167, v46, v47
    s_nop 0
    v_permlane16_swap_b32 v160, v162
    v_permlane16_swap_b32 v161, v163
    buffer_store_dwordx4 v[160:163], v16, s[52:55], s79 offen offset:0 sc1
    v_permlane16_swap_b32 v164, v166
    v_permlane16_swap_b32 v165, v167
    buffer_store_dwordx4 v[164:167], v16, s[52:55], s79 offen offset:1024 sc1
    s_add_u32 s79, s79, 2048
    s_nop 1
    v_cvt_pk_bf16_f32 v160, v48, v49
    v_cvt_pk_bf16_f32 v161, v50, v51
    v_cvt_pk_bf16_f32 v162, v52, v53
    v_cvt_pk_bf16_f32 v163, v54, v55
    v_cvt_pk_bf16_f32 v164, v56, v57
    v_cvt_pk_bf16_f32 v165, v58, v59
    v_cvt_pk_bf16_f32 v166, v60, v61
    v_cvt_pk_bf16_f32 v167, v62, v63
    s_nop 0
    v_permlane16_swap_b32 v160, v162
    v_permlane16_swap_b32 v161, v163
    buffer_store_dwordx4 v[160:163], v16, s[52:55], s79 offen offset:0 sc1
    v_permlane16_swap_b32 v164, v166
    v_permlane16_swap_b32 v165, v167
    buffer_store_dwordx4 v[164:167], v16, s[52:55], s79 offen offset:1024 sc1
    s_branch L_aux_cdone
L_help:
    s_sub_u32 s4, s3, 4
    v_lshrrev_b32 v1, 3, v0
    v_and_b32 v2, 7, v0
    s_and_b32 s6, s4, 1
    v_mul_u32_u24 v5, 3456, v1
    v_lshl_add_u32 v6, v2, 4, v5
    s_mul_i32 s14, s92, 276480
    s_lshl_b32 s9, s93, 7
    s_add_u32 s14, s14, s9
    v_lshrrev_b32 v3, 4, v0
    s_lshl_b32 s7, s6, 2
    v_or_b32 v3, s7, v3
    v_xor_b32 v3, v3, v2
    v_mul_u32_u24 v4, 1280, v1
    v_lshl_add_u32 v170, v3, 4, v4
    v_and_b32 v3, 2, v1
    v_or_b32 v3, s7, v3
    v_xor_b32 v3, v3, v2
    v_lshl_add_u32 v171, v3, 4, v5
    s_mul_i32 s8, s4, 27648
    s_add_u32 s8, s8, s9
    s_mul_i32 s9, s4, 10240
    s_mul_i32 s10, s92, 327680
    s_add_u32 s9, s9, s10
    s_lshl_b32 s10, s4, 10
    s_cmp_lt_u32 s92, 4
    s_cselect_b32 s5, 1105920, 0
    s_cselect_b32 s7, 640, 0
    s_add_u32 s8, s8, s5
    s_add_u32 s9, s9, s7
    s_lshr_b32 s15, s4, 1
    s_mul_i32 s15, s15, 138240
    s_add_u32 s14, s14, s15
    s_waitcnt lgkmcnt(0)
    s_cmp_eq_u32 s6, 0
    s_cselect_b32 s60, s32, s34
    s_cselect_b32 s61, s33, s35
    s_mov_b32 s62, 2211840
    s_mov_b32 s63, 0x20000
    s_mov_b32 s31, s14
    buffer_load_dwordx4 v[64:67], v6, s[60:63], s31 offen
    s_add_u32 s31, s31, 27648
    buffer_load_dwordx4 v[68:71], v6, s[60:63], s31 offen
    s_add_u32 s31, s31, 27648
    buffer_load_dwordx4 v[72:75], v6, s[60:63], s31 offen
    s_add_u32 s31, s31, 27648
    buffer_load_dwordx4 v[76:79], v6, s[60:63], s31 offen
    s_add_u32 s31, s31, 27648
    buffer_load_dwordx4 v[80:83], v6, s[60:63], s31 offen
    s_add_u32 s31, s31, 27648
    s_mov_b32 s44, s16
    s_mov_b32 s45, s17
    s_mov_b32 s46, 2621440
    s_mov_b32 s47, 0x20000
    s_mov_b32 s48, s32
    s_mov_b32 s49, s33
    s_mov_b32 s50, 2211840
    s_mov_b32 s51, 0x20000
    s_mov_b32 s52, s34
    s_mov_b32 s53, s35
    s_mov_b32 s54, 2211840
    s_mov_b32 s55, 0x20000
    s_add_u32 m0, s10, 98304
    s_add_u32 s11, s8, 0
    buffer_load_dwordx4 v171, s[48:51], s11 offen lds
    s_add_u32 m0, s10, 106496
    s_add_u32 s12, s9, 0
    buffer_load_dwordx4 v171, s[52:55], s11 offen lds
    s_add_u32 m0, s10, 114688
    s_add_u32 s11, s11, 110592
    buffer_load_dwordx4 v170, s[44:47], s12 offen lds
    s_lshl1_add_u32 s13, s93, s6
    s_lshl3_add_u32 s13, s13, s92
    s_lshr_b32 s15, s4, 1
    s_lshl1_add_u32 s13, s13, s15
    s_lshl_b32 s13, s13, 9
    s_add_u32 s13, s13, 166912
    s_add_u32 s56, s42, 65536
    s_addc_u32 s57, s43, 0
    s_mov_b32 s58, 2654208
    s_mov_b32 s59, 0x20000
    v_bfe_u32 v9, v0, 2, 2
    v_mul_u32_u24 v9, 1312, v9
    v_and_b32 v10, 3, v0
    v_lshl_add_u32 v9, v10, 3, v9
    v_lshrrev_b32 v10, 4, v0
    v_lshl_add_u32 v9, v10, 5, v9
    s_lshl_b32 s15, s4, 7
    s_add_u32 s15, s15, 147456
    v_add_u32 v9, s15, v9
    v_and_b32 v12, 1, v0
    v_lshlrev_b32 v12, 4, v12
    s_lshl_b32 s15, s4, 5
    v_add_u32 v12, s15, v12
    v_add_u32 v10, 157952, v12
    s_mul_i32 s72, s88, 10368
    s_add_u32 s72, s72, s10
    v_lshl_add_u32 v20, v0, 2, s4
    s_and_b32 s14, s4, 1
    s_add_u32 s14, s14, 52
    v_min_u32 v20, s14, v20
    v_lshlrev_b32 v18, 4, v0
    v_add_u32 v17, 4096, v18
    v_lshlrev_b32 v20, 7, v20
    s_lshr_b32 s14, s91, 1
    s_mul_i32 s14, s14, 6912
    s_add_u32 s14, s14, 20480
    s_add_u32 s64, s42, 5885952
    s_addc_u32 s65, s43, 0
    s_mov_b32 s66, 7077888
    s_mov_b32 s67, 0x20000
    s_add_u32 s68, s42, 3674112
    s_addc_u32 s69, s43, 0
    s_mov_b32 s70, 2211840
    s_mov_b32 s71, 0x20000
    s_mul_i32 s76, s91, 276480
    s_mul_i32 s82, s4, 5120
    s_add_u32 s76, s76, s82
    s_mul_i32 s77, s90, 221184
    s_lshl_b32 s78, s4, 12
    s_add_u32 s77, s77, s78
    s_add_u32 s82, s82, 43008
    s_add_u32 s84, s42, 15667200
    s_addc_u32 s85, s43, 0
    s_mov_b32 s86, 609280
    s_mov_b32 s87, 0x20000
    v_mul_u32_u24 v158, 6554, v0
    v_lshrrev_b32 v158, 16, v158
    v_mul_u32_u24 v158, 1120, v158
    v_add_u32 v158, v158, v18
    s_mul_i32 s29, s4, 2560
    s_add_u32 s29, s29, 147456
    v_and_b32 v159, 15, v0
    v_mul_u32_u24 v159, 160, v159
    v_lshrrev_b32 v157, 4, v0
    v_mul_u32_u24 v157, 40, v157
    v_add3_u32 v159, v159, v157, s29
    s_lshl2_add_u32 s28, s90, s4
    s_mul_i32 s28, s28, 20480
    s_mul_i32 s15, s91, 160
    s_add_u32 s28, s28, s15
    v_lshl_add_u32 v7, v2, 3, v1
    v_lshlrev_b32 v7, 3, v7
    s_add_u32 m0, s10, 102400
    s_nop 0
    buffer_load_dwordx4 v171, s[48:51], s11 offen lds
    s_add_u32 m0, s10, 110592
    s_nop 0
    buffer_load_dwordx4 v171, s[52:55], s11 offen lds
    s_add_u32 m0, s10, 118784
    s_add_u32 s12, s12, 40960
    buffer_load_dwordx4 v170, s[44:47], s12 offen lds
    s_add_u32 m0, s10, 122880
    s_add_u32 s12, s12, 40960
    buffer_load_dwordx4 v170, s[44:47], s12 offen lds
    s_add_u32 m0, s10, 126976
    s_add_u32 s12, s12, 40960
    buffer_load_dwordx4 v170, s[44:47], s12 offen lds
    s_add_u32 m0, s10, 131072
    s_add_u32 s12, s12, 40960
    buffer_load_dwordx4 v170, s[44:47], s12 offen lds
    s_add_u32 m0, s10, 135168
    s_add_u32 s12, s12, 40960
    buffer_load_dwordx4 v170, s[44:47], s12 offen lds
    s_add_u32 m0, s10, 139264
    s_add_u32 s12, s12, 40960
    buffer_load_dwordx4 v170, s[44:47], s12 offen lds
    s_add_u32 m0, s10, 143360
    s_add_u32 s12, s12, 40960
    buffer_load_dwordx4 v170, s[44:47], s12 offen lds
    v_mov_b32 v23, 0
    s_mov_b32 s74, 0x3f80
    s_mov_b32 s75, 0x3f800000
    s_add_u32 s60, s42, 0
    s_addc_u32 s61, s43, 0
    s_mov_b32 s62, 32768
    s_mov_b32 s63, 0x20000
    s_waitcnt vmcnt(12)
    s_add_u32 m0, s10, 0
    s_add_u32 s11, s8, 221184
    buffer_load_dwordx4 v171, s[48:51], s11 offen lds
    v_dot2_f32_bf16 v32, v64, s74, 0
    v_dot2_f32_bf16 v33, v64, s75, 0
    v_dot2_f32_bf16 v34, v65, s74, 0
    v_dot2_f32_bf16 v35, v65, s75, 0
    s_add_u32 m0, s10, 8192
    s_add_u32 s12, s9, 128
    buffer_load_dwordx4 v171, s[52:55], s11 offen lds
    v_dot2_f32_bf16 v36, v66, s74, 0
    v_dot2_f32_bf16 v37, v66, s75, 0
    v_dot2_f32_bf16 v38, v67, s74, 0
    v_dot2_f32_bf16 v39, v67, s75, 0
    s_add_u32 m0, s10, 16384
    s_add_u32 s11, s11, 110592
    buffer_load_dwordx4 v170, s[44:47], s12 offen lds
    v_dot2_f32_bf16 v32, v68, s74, v32
    v_dot2_f32_bf16 v33, v68, s75, v33
    v_dot2_f32_bf16 v34, v69, s74, v34
    v_dot2_f32_bf16 v35, v69, s75, v35
    s_add_u32 m0, s10, 4096
    s_nop 0
    buffer_load_dwordx4 v171, s[48:51], s11 offen lds
    v_dot2_f32_bf16 v36, v70, s74, v36
    v_dot2_f32_bf16 v37, v70, s75, v37
    v_dot2_f32_bf16 v38, v71, s74, v38
    v_dot2_f32_bf16 v39, v71, s75, v39
    s_add_u32 m0, s10, 12288
    s_nop 0
    buffer_load_dwordx4 v171, s[52:55], s11 offen lds
    v_dot2_f32_bf16 v32, v72, s74, v32
    v_dot2_f32_bf16 v33, v72, s75, v33
    v_dot2_f32_bf16 v34, v73, s74, v34
    v_dot2_f32_bf16 v35, v73, s75, v35
    s_add_u32 m0, s10, 20480
    s_add_u32 s12, s12, 40960
    buffer_load_dwordx4 v170, s[44:47], s12 offen lds
    v_dot2_f32_bf16 v36, v74, s74, v36
    v_dot2_f32_bf16 v37, v74, s75, v37
    v_dot2_f32_bf16 v38, v75, s74, v38
    v_dot2_f32_bf16 v39, v75, s75, v39
    s_add_u32 m0, s10, 24576
    s_add_u32 s12, s12, 40960
    buffer_load_dwordx4 v170, s[44:47], s12 offen lds
    v_dot2_f32_bf16 v32, v76, s74, v32
    v_dot2_f32_bf16 v33, v76, s75, v33
    v_dot2_f32_bf16 v34, v77, s74, v34
    v_dot2_f32_bf16 v35, v77, s75, v35
    s_add_u32 m0, s10, 28672
    s_add_u32 s12, s12, 40960
    buffer_load_dwordx4 v170, s[44:47], s12 offen lds
    v_dot2_f32_bf16 v36, v78, s74, v36
    v_dot2_f32_bf16 v37, v78, s75, v37
    v_dot2_f32_bf16 v38, v79, s74, v38
    v_dot2_f32_bf16 v39, v79, s75, v39
    s_add_u32 m0, s10, 32768
    s_add_u32 s12, s12, 40960
    buffer_load_dwordx4 v170, s[44:47], s12 offen lds
    v_dot2_f32_bf16 v32, v80, s74, v32
    v_dot2_f32_bf16 v33, v80, s75, v33
    v_dot2_f32_bf16 v34, v81, s74, v34
    v_dot2_f32_bf16 v35, v81, s75, v35
    s_add_u32 m0, s10, 36864
    s_add_u32 s12, s12, 40960
    buffer_load_dwordx4 v170, s[44:47], s12 offen lds
    v_dot2_f32_bf16 v36, v82, s74, v36
    v_dot2_f32_bf16 v37, v82, s75, v37
    v_dot2_f32_bf16 v38, v83, s74, v38
    v_dot2_f32_bf16 v39, v83, s75, v39
    s_add_u32 m0, s10, 40960
    s_add_u32 s12, s12, 40960
    buffer_load_dwordx4 v170, s[44:47], s12 offen lds
    s_nop 2
    v_permlane32_swap_b32 v32, v36
    v_permlane32_swap_b32 v33, v37
    v_permlane32_swap_b32 v34, v38
    s_add_u32 m0, s10, 45056
    s_add_u32 s12, s12, 40960
    buffer_load_dwordx4 v170, s[44:47], s12 offen lds
    v_permlane32_swap_b32 v35, v39
    v_add_f32 v32, v32, v36
    v_add_f32 v33, v33, v37
    v_add_f32 v34, v34, v38
    s_add_u32 m0, s10, 49152
    s_add_u32 s11, s8, 442368
    buffer_load_dwordx4 v171, s[48:51], s11 offen lds
    v_add_f32 v35, v35, v39
    s_nop 1
    v_permlane16_swap_b32 v32, v34
    v_permlane16_swap_b32 v33, v35
    s_add_u32 m0, s10, 57344
    s_add_u32 s12, s9, 256
    buffer_load_dwordx4 v171, s[52:55], s11 offen lds
    v_add_f32 v32, v32, v34
    v_add_f32 v33, v33, v35
    v_and_b32 v8, 8, v0
    v_cmp_ne_u32 vcc, 0, v8
    s_add_u32 m0, s10, 65536
    s_add_u32 s11, s11, 110592
    buffer_load_dwordx4 v170, s[44:47], s12 offen lds
    v_add_f32_dpp v32, v32, v32 row_ror:8 row_mask:0xf bank_mask:0xf
    v_add_f32_dpp v33, v33, v33 row_ror:8 row_mask:0xf bank_mask:0xf
    v_cndmask_b32 v168, v32, v33, vcc
    s_add_u32 m0, s10, 53248
    s_nop 0
    buffer_load_dwordx4 v171, s[48:51], s11 offen lds
    s_waitcnt vmcnt(16)
    s_barrier
    ds_read_b64_tr_b16 v[140:141], v9 offset:0
    ds_read_b64_tr_b16 v[142:143], v9 offset:5248
    ds_read_b64_tr_b16 v[144:145], v9 offset:512
    ds_read_b64_tr_b16 v[146:147], v9 offset:5760
    ds_read_b64_tr_b16 v[148:149], v9 offset:1024
    ds_read_b64_tr_b16 v[150:151], v9 offset:6272
    ds_read_b128 v[172:175], v10
    s_barrier
    global_load_dword v22, v23, s[40:41] sc1
    s_waitcnt lgkmcnt(0)
    buffer_store_dwordx4 v[140:143], v18, s[56:59], s72 offen sc1
    s_add_u32 s72, s72, 4096
    buffer_store_dwordx4 v[144:147], v18, s[56:59], s72 offen sc1
    s_add_u32 s72, s72, 4096
    s_cmp_ge_u32 s4, 2
    s_cmov_b32 s72, 0x40000000
    buffer_store_dwordx4 v[148:151], v18, s[56:59], s72 offen sc1
    s_add_u32 m0, s10, 61440
    s_nop 0
    buffer_load_dwordx4 v171, s[52:55], s11 offen lds
    s_add_u32 m0, s10, 69632
    s_add_u32 s12, s12, 40960
    buffer_load_dwordx4 v170, s[44:47], s12 offen lds
    s_add_u32 m0, s10, 73728
    s_add_u32 s12, s12, 40960
    buffer_load_dwordx4 v170, s[44:47], s12 offen lds
    s_add_u32 m0, s10, 77824
    s_add_u32 s12, s12, 40960
    buffer_load_dwordx4 v170, s[44:47], s12 offen lds
    s_add_u32 m0, s10, 81920
    s_add_u32 s12, s12, 40960
    buffer_load_dwordx4 v170, s[44:47], s12 offen lds
    s_add_u32 m0, s10, 86016
    s_add_u32 s12, s12, 40960
    buffer_load_dwordx4 v170, s[44:47], s12 offen lds
    s_add_u32 m0, s10, 90112
    s_add_u32 s12, s12, 40960
    buffer_load_dwordx4 v170, s[44:47], s12 offen lds
    s_add_u32 m0, s10, 94208
    s_add_u32 s12, s12, 40960
    buffer_load_dwordx4 v170, s[44:47], s12 offen lds
    s_waitcnt vmcnt(16)
    s_barrier
    s_waitcnt vmcnt(8)
L_nc_11:
    v_readfirstlane_b32 s95, v22
    s_cmp_lg_u32 s95, 0
    s_cbranch_scc1 L_nc_12
    s_add_u32 s89, s89, 1
    s_cmp_ge_u32 s89, 400000
    s_cbranch_scc1 L_nc_12
    s_sleep 4
    global_load_dword v22, v23, s[40:41] sc1
    s_waitcnt vmcnt(0)
    s_branch L_nc_11
L_nc_12:
    v_mov_b32 v169, v22
    v_mov_b32 v175, v22
    s_lshl_b32 s15, s88, 7
    s_mov_b64 exec, 3
    buffer_store_dwordx4 v[172:175], v12, s[60:63], s15 offen sc1
    s_mov_b64 exec, -1
    buffer_store_dwordx2 v[168:169], v7, s[84:87], s13 offen sc1
    s_add_u32 m0, s10, 98304
    s_add_u32 s11, s8, 663552
    buffer_load_dwordx4 v171, s[48:51], s11 offen lds
    s_add_u32 m0, s10, 106496
    s_add_u32 s12, s9, 384
    buffer_load_dwordx4 v171, s[52:55], s11 offen lds
    s_add_u32 m0, s10, 114688
    s_add_u32 s11, s11, 110592
    buffer_load_dwordx4 v170, s[44:47], s12 offen lds
    s_add_u32 m0, s10, 102400
    s_nop 0
    buffer_load_dwordx4 v171, s[48:51], s11 offen lds
    s_add_u32 m0, s10, 110592
    s_nop 0
    buffer_load_dwordx4 v171, s[52:55], s11 offen lds
    s_add_u32 m0, s10, 118784
    s_add_u32 s12, s12, 40960
    buffer_load_dwordx4 v170, s[44:47], s12 offen lds
    s_add_u32 m0, s10, 122880
    s_add_u32 s12, s12, 40960
    buffer_load_dwordx4 v170, s[44:47], s12 offen lds
    s_add_u32 m0, s10, 126976
    s_add_u32 s12, s12, 40960
    buffer_load_dwordx4 v170, s[44:47], s12 offen lds
    s_add_u32 m0, s10, 131072
    s_add_u32 s12, s12, 40960
    buffer_load_dwordx4 v170, s[44:47], s12 offen lds
    s_add_u32 m0, s10, 135168
    s_add_u32 s12, s12, 40960
    buffer_load_dwordx4 v170, s[44:47], s12 offen lds
    s_add_u32 m0, s10, 139264
    s_add_u32 s12, s12, 40960
    buffer_load_dwordx4 v170, s[44:47], s12 offen lds
    s_add_u32 m0, s10, 143360
    s_add_u32 s12, s12, 40960
    buffer_load_dwordx4 v170, s[44:47], s12 offen lds
    s_waitcnt vmcnt(14)
    s_barrier
    s_lshr_b32 s27, s4, 1
    s_lshl1_add_u32 s27, s93, s27
    s_lshl_b32 s27, s27, 13
    s_lshl_b32 s15, s6, 8
    s_add_u32 s27, s27, s15
    s_add_u32 s27, s27, 166912
    s_add_u32 s16, s27, 4096
    v_lshrrev_b32 v156, 4, v0
    v_lshl_add_u32 v156, v156, 8, v18
    s_lshl_b32 s75, s92, 12
    s_add_u32 s75, s75, s10
    s_and_b32 s72, s2, 31
    s_lshl_b32 s72, s72, 9
    v_and_b32 v8, 3, v0
    v_lshlrev_b32 v8, 7, v8
    s_and_b32 s26, s4, 1
    s_mul_i32 s73, s26, 15104
    s_mul_i32 s26, s26, 1536
    s_add_u32 s26, s26, 158720
    s_add_u32 m0, s10, 0
    s_add_u32 s11, s8, 884736
    buffer_load_dwordx4 v171, s[48:51], s11 offen lds
    v_and_b32 v10, 15, v0
    v_lshrrev_b32 v11, 4, v0
    v_mul_u32_u24 v12, 1280, v10
    s_add_u32 m0, s10, 8192
    s_add_u32 s12, s9, 512
    buffer_load_dwordx4 v171, s[52:55], s11 offen lds
    v_mul_u32_u24 v15, 40, v11
    v_add_u32 v12, v12, v15
    s_lshl2_add_u32 s20, s90, s4
    s_add_u32 m0, s10, 16384
    s_add_u32 s11, s11, 110592
    buffer_load_dwordx4 v170, s[44:47], s12 offen lds
    s_mul_i32 s20, s20, 20480
    s_mul_i32 s23, s91, 160
    s_add_u32 s20, s20, s23
    s_add_u32 m0, s10, 4096
    s_nop 0
    buffer_load_dwordx4 v171, s[48:51], s11 offen lds
    s_add_u32 s18, s4, 0
    s_and_b32 s18, s18, 3
    s_lshl_b32 s18, s18, 10
    s_add_u32 m0, s10, 12288
    s_nop 0
    buffer_load_dwordx4 v171, s[52:55], s11 offen lds
    v_add_u32 v2, s18, v18
    s_add_u32 s18, s4, 1
    s_and_b32 s18, s18, 3
    s_add_u32 m0, s10, 20480
    s_add_u32 s12, s12, 40960
    buffer_load_dwordx4 v170, s[44:47], s12 offen lds
    s_lshl_b32 s18, s18, 10
    v_add_u32 v3, s18, v18
    s_add_u32 s18, s4, 2
    s_add_u32 m0, s10, 24576
    s_add_u32 s12, s12, 40960
    buffer_load_dwordx4 v170, s[44:47], s12 offen lds
    s_and_b32 s18, s18, 3
    s_lshl_b32 s18, s18, 10
    v_add_u32 v4, s18, v18
    s_add_u32 m0, s10, 28672
    s_add_u32 s12, s12, 40960
    buffer_load_dwordx4 v170, s[44:47], s12 offen lds
    s_add_u32 s18, s4, 3
    s_and_b32 s18, s18, 3
    s_lshl_b32 s18, s18, 10
    s_add_u32 m0, s10, 32768
    s_add_u32 s12, s12, 40960
    buffer_load_dwordx4 v170, s[44:47], s12 offen lds
    v_add_u32 v5, s18, v18
    v_add_u32 v6, s82, v18
    v_add_u32 v7, 61440, v6
    s_add_u32 m0, s10, 36864
    s_add_u32 s12, s12, 40960
    buffer_load_dwordx4 v170, s[44:47], s12 offen lds
    s_lshr_b32 s18, s90, 1
    s_mul_i32 s18, s18, 6912
    s_add_u32 s18, s18, 48128
    s_add_u32 m0, s10, 40960
    s_add_u32 s12, s12, 40960
    buffer_load_dwordx4 v170, s[44:47], s12 offen lds
    s_add_u32 m0, s10, 45056
    s_add_u32 s12, s12, 40960
    buffer_load_dwordx4 v170, s[44:47], s12 offen lds
    s_waitcnt vmcnt(12)
    s_barrier
    s_sub_u32 s8, s8, s5
    s_sub_u32 s8, s8, s5
    s_sub_u32 s9, s9, s7
    s_sub_u32 s9, s9, s7
    s_add_u32 m0, s10, 49152
    s_add_u32 s11, s8, 1105920
    buffer_load_dwordx4 v171, s[48:51], s11 offen lds
    v_min_u32 v9, 19, v0
    v_lshlrev_b32 v9, 2, v9
    s_lshr_b32 s19, s90, 4
    s_add_u32 m0, s10, 57344
    s_add_u32 s12, s9, 640
    buffer_load_dwordx4 v171, s[52:55], s11 offen lds
    s_lshl3_add_u32 s19, s19, s91
    s_lshl2_add_u32 s19, s19, s4
    s_lshl_b32 s19, s19, 7
    s_add_u32 m0, s10, 65536
    s_add_u32 s11, s11, 110592
    buffer_load_dwordx4 v170, s[44:47], s12 offen lds
    s_add_u32 s19, s19, 158720
    s_lshl2_add_u32 s21, s91, s4
    s_mul_i32 s21, s21, 84480
    s_add_u32 m0, s10, 53248
    s_nop 0
    buffer_load_dwordx4 v171, s[48:51], s11 offen lds
    s_lshl_b32 s23, s90, 7
    s_add_u32 s21, s21, s23
    v_lshrrev_b32 v14, 3, v0
    s_add_u32 m0, s10, 61440
    s_nop 0
    buffer_load_dwordx4 v171, s[52:55], s11 offen lds
    v_and_b32 v15, 2, v14
    s_and_b32 s23, s4, 1
    s_lshl_b32 s23, s23, 2
    s_add_u32 m0, s10, 69632
    s_add_u32 s12, s12, 40960
    buffer_load_dwordx4 v170, s[44:47], s12 offen lds
    v_or_b32 v15, s23, v15
    v_and_b32 v16, 7, v0
    v_xor_b32 v15, v15, v16
    s_add_u32 m0, s10, 73728
    s_add_u32 s12, s12, 40960
    buffer_load_dwordx4 v170, s[44:47], s12 offen lds
    v_mul_u32_u24 v14, 4224, v14
    v_lshl_add_u32 v14, v15, 4, v14
    v_lshrrev_b32 v15, 2, v10
    s_add_u32 m0, s10, 77824
    s_add_u32 s12, s12, 40960
    buffer_load_dwordx4 v170, s[44:47], s12 offen lds
    v_lshrrev_b32 v16, 1, v15
    v_and_b32 v21, 1, v11
    v_lshl_add_u32 v16, v21, 1, v16
    s_add_u32 m0, s10, 81920
    s_add_u32 s12, s12, 40960
    buffer_load_dwordx4 v170, s[44:47], s12 offen lds
    v_xor_b32 v16, s4, v16
    v_lshlrev_b32 v15, 7, v15
    v_lshl_add_u32 v15, v16, 5, v15
    s_add_u32 m0, s10, 86016
    s_add_u32 s12, s12, 40960
    buffer_load_dwordx4 v170, s[44:47], s12 offen lds
    v_and_b32 v16, 3, v0
    v_lshl_add_u32 v15, v16, 3, v15
    v_mul_u32_u24 v16, 5120, v11
    s_add_u32 m0, s10, 90112
    s_add_u32 s12, s12, 40960
    buffer_load_dwordx4 v170, s[44:47], s12 offen lds
    s_add_u32 m0, s10, 94208
    s_add_u32 s12, s12, 40960
    buffer_load_dwordx4 v170, s[44:47], s12 offen lds
    s_add_u32 m0, s29, 0
    s_mov_b32 exec_hi, 0x0fffffff
    buffer_load_dwordx4 v158, s[44:47], s28 offen lds
    s_mov_b32 exec_hi, -1
    s_add_u32 s28, s28, 7680
    s_add_u32 m0, s29, 960
    s_mov_b32 exec_hi, 0x0fffffff
    buffer_load_dwordx4 v158, s[44:47], s28 offen lds
    s_mov_b32 exec_hi, -1
    s_add_u32 s28, s28, 7680
    s_waitcnt vmcnt(14)
    s_barrier
    s_add_u32 m0, s10, 98304
    s_add_u32 s11, s8, 1327104
    buffer_load_dwordx4 v171, s[48:51], s11 offen lds
    v_add_u32 v15, v15, v16
    v_add_u32 v15, 104448, v15
    s_sub_u32 s23, s4, 1
    s_add_u32 m0, s10, 106496
    s_add_u32 s12, s9, 768
    buffer_load_dwordx4 v171, s[52:55], s11 offen lds
    s_and_b32 s23, s23, 3
    s_mul_i32 s23, s23, 5120
    s_add_u32 s23, s23, 43008
    s_add_u32 m0, s10, 114688
    s_add_u32 s11, s11, 110592
    buffer_load_dwordx4 v170, s[44:47], s12 offen lds
    v_add_u32 v25, s23, v18
    s_sub_u32 s23, s4, 2
    s_and_b32 s23, s23, 3
    s_add_u32 m0, s10, 102400
    s_nop 0
    buffer_load_dwordx4 v171, s[48:51], s11 offen lds
    s_mul_i32 s23, s23, 5120
    s_add_u32 s23, s23, 63488
    v_add_u32 v26, s23, v18
    s_add_u32 m0, s10, 110592
    s_nop 0
    buffer_load_dwordx4 v171, s[52:55], s11 offen lds
    s_sub_u32 s23, s4, 3
    s_and_b32 s23, s23, 3
    s_mul_i32 s23, s23, 5120
    s_add_u32 m0, s10, 118784
    s_add_u32 s12, s12, 40960
    buffer_load_dwordx4 v170, s[44:47], s12 offen lds
    s_add_u32 s23, s23, 83968
    v_add_u32 v27, s23, v18
    s_mov_b32 s22, 0xffff0000
    s_add_u32 m0, s10, 122880
    s_add_u32 s12, s12, 40960
    buffer_load_dwordx4 v170, s[44:47], s12 offen lds
    v_mul_u32_u24 v10, 160, v10
    v_mul_u32_u24 v11, 40, v11
    s_add_u32 s23, s82, 81920
    s_add_u32 m0, s10, 126976
    s_add_u32 s12, s12, 40960
    buffer_load_dwordx4 v170, s[44:47], s12 offen lds
    v_add3_u32 v10, v10, v11, s23
    v_mul_u32_u24 v11, 6554, v0
    v_lshrrev_b32 v11, 16, v11
    s_add_u32 m0, s10, 131072
    s_add_u32 s12, s12, 40960
    buffer_load_dwordx4 v170, s[44:47], s12 offen lds
    v_mul_u32_u24 v11, 1120, v11
    v_add_u32 v11, v11, v18
    s_add_u32 m0, s10, 135168
    s_add_u32 s12, s12, 40960
    buffer_load_dwordx4 v170, s[44:47], s12 offen lds
    s_add_u32 m0, s10, 139264
    s_add_u32 s12, s12, 40960
    buffer_load_dwordx4 v170, s[44:47], s12 offen lds
    s_add_u32 m0, s10, 143360
    s_add_u32 s12, s12, 40960
    buffer_load_dwordx4 v170, s[44:47], s12 offen lds
    s_add_u32 m0, s29, 1920
    s_mov_b32 exec_hi, 0xff
    buffer_load_dwordx4 v158, s[44:47], s28 offen lds
    s_mov_b32 exec_hi, -1
    s_add_u32 s28, s28, 7680
    buffer_load_dwordx4 v[152:155], v18, s[60:63], s75 offen sc1
    s_waitcnt vmcnt(16)
    s_barrier
    s_cmp_ge_u32 s4, 2
    s_cbranch_scc1 L_p_13
    s_add_u32 m0, s10, 0
    s_add_u32 s11, s8, 1548288
    buffer_load_dwordx4 v171, s[48:51], s11 offen lds
    s_mov_b32 s24, 0x01000100
    s_mov_b32 s25, 0x03020302
    s_add_u32 m0, s10, 8192
    s_add_u32 s12, s9, 896
    buffer_load_dwordx4 v171, s[52:55], s11 offen lds
    v_lshlrev_b32 v218, 3, v0
    v_add_u32 v222, s26, v218
    s_add_u32 m0, s10, 16384
    s_add_u32 s11, s11, 110592
    buffer_load_dwordx4 v170, s[44:47], s12 offen lds
    v_lshlrev_b32 v223, 2, v0
    v_add_u32 v223, s26, v223
    s_add_u32 m0, s10, 4096
    s_nop 0
    buffer_load_dwordx4 v171, s[48:51], s11 offen lds
    ds_read_b64 v[208:209], v222
    ds_read_b64 v[210:211], v222 offset:8
    s_add_u32 m0, s10, 12288
    s_nop 0
    buffer_load_dwordx4 v171, s[52:55], s11 offen lds
    ds_read2_b32 v[212:213], v223 offset0:128 offset1:129
    v_mov_b32 v216, 0
    s_add_u32 m0, s10, 20480
    s_add_u32 s12, s12, 40960
    buffer_load_dwordx4 v170, s[44:47], s12 offen lds
    v_mov_b32 v217, 0
    v_add_u32 v218, s73, v218
    s_add_u32 m0, s10, 24576
    s_add_u32 s12, s12, 40960
    buffer_load_dwordx4 v170, s[44:47], s12 offen lds
    v_and_b32 v222, 3, v0
    v_bfe_u32 v223, v0, 2, 2
    s_add_u32 m0, s10, 28672
    s_add_u32 s12, s12, 40960
    buffer_load_dwordx4 v170, s[44:47], s12 offen lds
    v_mul_u32_u24 v223, 2624, v223
    v_lshl_add_u32 v223, v222, 3, v223
    s_add_u32 m0, s10, 32768
    s_add_u32 s12, s12, 40960
    buffer_load_dwordx4 v170, s[44:47], s12 offen lds
    v_add_u32 v223, s73, v223
    v_cmp_eq_u32 vcc, 63, v0
    s_add_u32 m0, s10, 36864
    s_add_u32 s12, s12, 40960
    buffer_load_dwordx4 v170, s[44:47], s12 offen lds
    v_mov_b32 v220, 0x03020100
    v_mov_b32 v222, 0x01000100
    v_cndmask_b32 v220, v220, v222, vcc
    s_add_u32 m0, s10, 40960
    s_add_u32 s12, s12, 40960
    buffer_load_dwordx4 v170, s[44:47], s12 offen lds
    v_mov_b32 v221, 0x07060504
    s_add_u32 m0, s10, 45056
    s_add_u32 s12, s12, 40960
    buffer_load_dwordx4 v170, s[44:47], s12 offen lds
    s_branch L_p_14
L_p_13:
    s_add_u32 m0, s10, 0
    s_add_u32 s11, s8, 1548288
    buffer_load_dwordx4 v171, s[48:51], s11 offen lds
    s_mov_b32 s24, 0x01000100
    s_mov_b32 s25, 0x03020302
    s_add_u32 m0, s10, 8192
    s_add_u32 s12, s9, 896
    buffer_load_dwordx4 v171, s[52:55], s11 offen lds
    v_lshl_add_u32 v212, v0, 2, s26
    v_add_u32 v213, 1024, v212
    s_add_u32 m0, s10, 16384
    s_add_u32 s11, s11, 110592
    buffer_load_dwordx4 v170, s[44:47], s12 offen lds
    ds_read2_b32 v[208:209], v212 offset0:192 offset1:193
    ds_read2_b32 v[210:211], v213 offset0:0 offset1:1
    s_add_u32 m0, s10, 4096
    s_nop 0
    buffer_load_dwordx4 v171, s[48:51], s11 offen lds
    v_lshl_add_u32 v212, v0, 4, s73
    v_lshl_add_u32 v213, v0, 1, s73
    s_add_u32 m0, s10, 12288
    s_nop 0
    buffer_load_dwordx4 v171, s[52:55], s11 offen lds
    v_mov_b32 v215, s73
    v_mov_b32 v216, 0
    s_add_u32 m0, s10, 20480
    s_add_u32 s12, s12, 40960
    buffer_load_dwordx4 v170, s[44:47], s12 offen lds
    v_mov_b32 v217, 0
    v_mov_b32 v218, 0
    s_add_u32 m0, s10, 24576
    s_add_u32 s12, s12, 40960
    buffer_load_dwordx4 v170, s[44:47], s12 offen lds
    v_mov_b32 v219, 0
    v_lshrrev_b32 v214, 5, v0
    s_add_u32 m0, s10, 28672
    s_add_u32 s12, s12, 40960
    buffer_load_dwordx4 v170, s[44:47], s12 offen lds
    v_mul_u32_u24 v214, 2112, v214
    v_add_u32 v214, v214, v212
    s_add_u32 m0, s10, 32768
    s_add_u32 s12, s12, 40960
    buffer_load_dwordx4 v170, s[44:47], s12 offen lds
    s_waitcnt lgkmcnt(0)
    v_perm_b32 v220, v208, v208, s24
    s_add_u32 m0, s10, 36864
    s_add_u32 s12, s12, 40960
    buffer_load_dwordx4 v170, s[44:47], s12 offen lds
    s_add_u32 m0, s10, 40960
    s_add_u32 s12, s12, 40960
    buffer_load_dwordx4 v170, s[44:47], s12 offen lds
    s_add_u32 m0, s10, 45056
    s_add_u32 s12, s12, 40960
    buffer_load_dwordx4 v170, s[44:47], s12 offen lds
L_p_14:
    buffer_load_dwordx4 v[136:139], v156, s[84:87], s27 offen offset:0 sc1
    buffer_load_dwordx4 v[140:143], v156, s[84:87], s27 offen offset:2048 sc1
    s_waitcnt vmcnt(16)
    s_barrier
    buffer_load_dword v24, v20, s[84:87], s14 offen sc1
    s_cmp_ge_u32 s4, 2
    s_cbranch_scc1 L_p_15
    s_add_u32 m0, s10, 49152
    s_add_u32 s11, s8, 1769472
    buffer_load_dwordx4 v171, s[48:51], s11 offen lds
    v_mov_b32 v222, 0x03020302
    v_cndmask_b32 v221, v221, v222, vcc
    s_add_u32 m0, s10, 57344
    s_add_u32 s12, s9, 1024
    buffer_load_dwordx4 v171, s[52:55], s11 offen lds
    s_waitcnt lgkmcnt(0)
    v_perm_b32 v211, v211, v210, v221
    s_add_u32 m0, s10, 65536
    s_add_u32 s11, s11, 110592
    buffer_load_dwordx4 v170, s[44:47], s12 offen lds
    v_perm_b32 v210, v210, v210, v220
    v_alignbit_b32 v224, v209, v208, 16
    s_add_u32 m0, s10, 53248
    s_nop 0
    buffer_load_dwordx4 v171, s[48:51], s11 offen lds
    v_alignbit_b32 v225, v210, v209, 16
    v_mov_b32 v226, v209
    s_add_u32 m0, s10, 61440
    s_nop 0
    buffer_load_dwordx4 v171, s[52:55], s11 offen lds
    v_mov_b32 v227, v210
    v_alignbit_b32 v228, v210, v209, 16
    s_add_u32 m0, s10, 69632
    s_add_u32 s12, s12, 40960
    buffer_load_dwordx4 v170, s[44:47], s12 offen lds
    v_alignbit_b32 v229, v211, v210, 16
    v_lshlrev_b32 v230, 16, v208
    s_add_u32 m0, s10, 73728
    s_add_u32 s12, s12, 40960
    buffer_load_dwordx4 v170, s[44:47], s12 offen lds
    v_alignbit_b32 v231, v209, v208, 16
    v_perm_b32 v213, v213, v213, v220
    s_add_u32 m0, s10, 77824
    s_add_u32 s12, s12, 40960
    buffer_load_dwordx4 v170, s[44:47], s12 offen lds
    v_perm_b32 v232, v212, v212, s24
    v_alignbit_b32 v233, v213, v212, 16
    s_add_u32 m0, s10, 81920
    s_add_u32 s12, s12, 40960
    buffer_load_dwordx4 v170, s[44:47], s12 offen lds
    v_mov_b32 v234, v212
    v_perm_b32 v235, v213, v213, s24
    s_add_u32 m0, s10, 86016
    s_add_u32 s12, s12, 40960
    buffer_load_dwordx4 v170, s[44:47], s12 offen lds
    v_alignbit_b32 v236, v213, v212, 16
    v_perm_b32 v237, v213, v213, s24
    s_add_u32 m0, s10, 90112
    s_add_u32 s12, s12, 40960
    buffer_load_dwordx4 v170, s[44:47], s12 offen lds
    v_perm_b32 v238, v213, v213, s24
    v_mov_b32 v239, v213
    s_add_u32 m0, s10, 94208
    s_add_u32 s12, s12, 40960
    buffer_load_dwordx4 v170, s[44:47], s12 offen lds
    s_branch L_p_16
L_p_15:
    s_add_u32 m0, s10, 49152
    s_add_u32 s11, s8, 1769472
    buffer_load_dwordx4 v171, s[48:51], s11 offen lds
    v_mov_b32 v221, v208
    v_perm_b32 v222, v208, v208, s25
    s_add_u32 m0, s10, 57344
    s_add_u32 s12, s9, 1024
    buffer_load_dwordx4 v171, s[52:55], s11 offen lds
    v_perm_b32 v223, v209, v209, s24
    v_perm_b32 v224, v208, v208, s24
    s_add_u32 m0, s10, 65536
    s_add_u32 s11, s11, 110592
    buffer_load_dwordx4 v170, s[44:47], s12 offen lds
    v_perm_b32 v225, v208, v208, s25
    v_alignbit_b32 v226, v209, v208, 16
    s_add_u32 m0, s10, 53248
    s_nop 0
    buffer_load_dwordx4 v171, s[48:51], s11 offen lds
    v_perm_b32 v227, v209, v209, s24
    v_mov_b32 v228, v208
    s_add_u32 m0, s10, 61440
    s_nop 0
    buffer_load_dwordx4 v171, s[52:55], s11 offen lds
    v_perm_b32 v229, v208, v208, s25
    v_perm_b32 v230, v209, v209, s24
    s_add_u32 m0, s10, 69632
    s_add_u32 s12, s12, 40960
    buffer_load_dwordx4 v170, s[44:47], s12 offen lds
    v_perm_b32 v231, v209, v209, s24
    v_perm_b32 v232, v208, v208, s25
    s_add_u32 m0, s10, 73728
    s_add_u32 s12, s12, 40960
    buffer_load_dwordx4 v170, s[44:47], s12 offen lds
    v_alignbit_b32 v233, v209, v208, 16
    v_perm_b32 v234, v209, v209, s24
    s_add_u32 m0, s10, 77824
    s_add_u32 s12, s12, 40960
    buffer_load_dwordx4 v170, s[44:47], s12 offen lds
    v_perm_b32 v235, v209, v209, s24
    v_perm_b32 v236, v210, v210, s24
    s_add_u32 m0, s10, 81920
    s_add_u32 s12, s12, 40960
    buffer_load_dwordx4 v170, s[44:47], s12 offen lds
    v_perm_b32 v237, v210, v210, s24
    v_and_b32 v238, 0xffff, v210
    s_add_u32 m0, s10, 86016
    s_add_u32 s12, s12, 40960
    buffer_load_dwordx4 v170, s[44:47], s12 offen lds
    s_add_u32 m0, s10, 90112
    s_add_u32 s12, s12, 40960
    buffer_load_dwordx4 v170, s[44:47], s12 offen lds
    s_add_u32 m0, s10, 94208
    s_add_u32 s12, s12, 40960
    buffer_load_dwordx4 v170, s[44:47], s12 offen lds
L_p_16:
    buffer_load_dwordx4 v[144:147], v156, s[84:87], s16 offen offset:0 sc1
    buffer_load_dwordx4 v[148:151], v156, s[84:87], s16 offen offset:2048 sc1
    s_waitcnt vmcnt(17)
    s_barrier
    s_waitcnt vmcnt(14)
L_w2c_17:
    v_cmp_ne_u32 vcc, s95, v24
    s_cmp_eq_u64 vcc, 0
    s_cbranch_scc1 L_w2c_18
    s_add_u32 s89, s89, 1
    s_cmp_ge_u32 s89, 400000
    s_cbranch_scc1 L_w2c_18
    s_sleep 8
    buffer_load_dword v24, v20, s[84:87], s14 offen sc1
    s_waitcnt vmcnt(0)
    s_branch L_w2c_17
L_w2c_18:
    s_add_u32 m0, s10, 98304
    s_add_u32 s11, s8, 1990656
    buffer_load_dwordx4 v171, s[48:51], s11 offen lds
    ds_read_b64 v[196:197], v159 offset:0
    ds_read_b64 v[198:199], v159 offset:8
    ds_read_b64 v[200:201], v159 offset:16
    s_add_u32 m0, s10, 106496
    s_add_u32 s12, s9, 1152
    buffer_load_dwordx4 v171, s[52:55], s11 offen lds
    ds_read_b64 v[202:203], v159 offset:24
    ds_read_b64 v[204:205], v159 offset:32
    s_waitcnt lgkmcnt(0)
    s_add_u32 m0, s10, 114688
    s_add_u32 s11, s11, 110592
    buffer_load_dwordx4 v170, s[44:47], s12 offen lds
    v_lshlrev_b32 v176, 16, v196
    v_and_b32 v177, s22, v196
    v_lshlrev_b32 v178, 16, v197
    s_add_u32 m0, s10, 102400
    s_nop 0
    buffer_load_dwordx4 v171, s[48:51], s11 offen lds
    v_and_b32 v179, s22, v197
    v_lshlrev_b32 v180, 16, v198
    v_and_b32 v181, s22, v198
    s_add_u32 m0, s10, 110592
    s_nop 0
    buffer_load_dwordx4 v171, s[52:55], s11 offen lds
    v_lshlrev_b32 v182, 16, v199
    v_and_b32 v183, s22, v199
    v_lshlrev_b32 v184, 16, v200
    s_add_u32 m0, s10, 118784
    s_add_u32 s12, s12, 40960
    buffer_load_dwordx4 v170, s[44:47], s12 offen lds
    v_and_b32 v185, s22, v200
    v_lshlrev_b32 v186, 16, v201
    v_and_b32 v187, s22, v201
    s_add_u32 m0, s10, 122880
    s_add_u32 s12, s12, 40960
    buffer_load_dwordx4 v170, s[44:47], s12 offen lds
    v_lshlrev_b32 v188, 16, v202
    v_and_b32 v189, s22, v202
    v_lshlrev_b32 v190, 16, v203
    s_add_u32 m0, s10, 126976
    s_add_u32 s12, s12, 40960
    buffer_load_dwordx4 v170, s[44:47], s12 offen lds
    v_and_b32 v191, s22, v203
    v_lshlrev_b32 v192, 16, v204
    v_and_b32 v193, s22, v204
    s_add_u32 m0, s10, 131072
    s_add_u32 s12, s12, 40960
    buffer_load_dwordx4 v170, s[44:47], s12 offen lds
    v_lshlrev_b32 v194, 16, v205
    v_and_b32 v195, s22, v205
    s_add_u32 m0, s10, 135168
    s_add_u32 s12, s12, 40960
    buffer_load_dwordx4 v170, s[44:47], s12 offen lds
    s_add_u32 m0, s10, 139264
    s_add_u32 s12, s12, 40960
    buffer_load_dwordx4 v170, s[44:47], s12 offen lds
    s_add_u32 m0, s10, 143360
    s_add_u32 s12, s12, 40960
    buffer_load_dwordx4 v170, s[44:47], s12 offen lds
    buffer_load_dword v13, v8, s[84:87], s72 offen offset:0 sc1
    s_waitcnt vmcnt(15)
    s_barrier
    s_add_u32 s79, s76, 0
    buffer_load_dwordx4 v[28:31], v18, s[68:71], s79 offen offset:0 sc1
    buffer_load_dwordx4 v[32:35], v18, s[68:71], s79 offen offset:1024 sc1
    buffer_load_dwordx4 v[36:39], v18, s[68:71], s79 offen offset:2048 sc1
    buffer_load_dwordx4 v[40:43], v18, s[68:71], s79 offen offset:3072 sc1
    buffer_load_dwordx4 v[44:47], v17, s[68:71], s79 offen sc1
    s_add_u32 s79, s76, 20480
    buffer_load_dwordx4 v[48:51], v18, s[68:71], s79 offen offset:0 sc1
    buffer_load_dwordx4 v[52:55], v18, s[68:71], s79 offen offset:1024 sc1
    buffer_load_dwordx4 v[56:59], v18, s[68:71], s79 offen offset:2048 sc1
    buffer_load_dwordx4 v[60:63], v18, s[68:71], s79 offen offset:3072 sc1
    buffer_load_dwordx4 v[64:67], v17, s[68:71], s79 offen sc1
    s_add_u32 s79, s76, 143360
    buffer_load_dwordx4 v[68:71], v18, s[68:71], s79 offen offset:0 sc1
    buffer_load_dwordx4 v[72:75], v18, s[68:71], s79 offen offset:1024 sc1
    buffer_load_dwordx4 v[76:79], v18, s[68:71], s79 offen offset:2048 sc1
    buffer_load_dwordx4 v[80:83], v18, s[68:71], s79 offen offset:3072 sc1
    buffer_load_dwordx4 v[84:87], v17, s[68:71], s79 offen sc1
    s_add_u32 s79, s76, 163840
    buffer_load_dwordx4 v[88:91], v18, s[68:71], s79 offen offset:0 sc1
    buffer_load_dwordx4 v[92:95], v18, s[68:71], s79 offen offset:1024 sc1
    s_waitcnt vmcnt(17)
    s_barrier
L_chk_19:
    v_cmp_ne_u32 vcc, s95, v13
    v_cmp_ne_u32 s[80:81], s95, v155
    s_or_b64 vcc, vcc, s[80:81]
    v_cmp_ne_u32 s[80:81], s95, v137
    s_or_b64 vcc, vcc, s[80:81]
    v_cmp_ne_u32 s[80:81], s95, v139
    s_or_b64 vcc, vcc, s[80:81]
    v_cmp_ne_u32 s[80:81], s95, v141
    s_or_b64 vcc, vcc, s[80:81]
    v_cmp_ne_u32 s[80:81], s95, v143
    s_or_b64 vcc, vcc, s[80:81]
    v_cmp_ne_u32 s[80:81], s95, v145
    s_or_b64 vcc, vcc, s[80:81]
    v_cmp_ne_u32 s[80:81], s95, v147
    s_or_b64 vcc, vcc, s[80:81]
    v_cmp_ne_u32 s[80:81], s95, v149
    s_or_b64 vcc, vcc, s[80:81]
    v_cmp_ne_u32 s[80:81], s95, v151
    s_or_b64 vcc, vcc, s[80:81]
    s_cmp_eq_u64 vcc, 0
    s_cbranch_scc1 L_chk_20
    s_add_u32 s89, s89, 1
    s_cmp_ge_u32 s89, 400000
    s_cbranch_scc1 L_chk_20
    s_sleep 8
    buffer_load_dword v13, v8, s[84:87], s72 offen offset:0 sc1
    buffer_load_dwordx4 v[136:139], v156, s[84:87], s27 offen offset:0 sc1
    buffer_load_dwordx4 v[140:143], v156, s[84:87], s27 offen offset:2048 sc1
    buffer_load_dwordx4 v[144:147], v156, s[84:87], s16 offen offset:0 sc1
    buffer_load_dwordx4 v[148:151], v156, s[84:87], s16 offen offset:2048 sc1
    buffer_load_dwordx4 v[152:155], v18, s[60:63], s75 offen sc1
    s_waitcnt vmcnt(0)
    s_branch L_chk_19
L_chk_20:
    v_lshrrev_b32 v16, 1, v0
    v_and_b32 v21, 1, v0
    v_mul_u32_u24 v24, 10368, v16
    v_lshl_add_u32 v24, v21, 4, v24
    s_lshl_b32 s13, s94, 5
    s_mul_i32 s8, s4, 663552
    s_add_u32 s13, s13, s8
    buffer_load_dwordx4 v[160:163], v24, s[56:59], s13 offen sc1
    s_add_u32 s13, s13, 331776
    buffer_load_dwordx4 v[164:167], v24, s[56:59], s13 offen sc1
    v_mul_u32_u24 v13, 15104, v21
    v_lshl_add_u32 v13, v16, 4, v13
    v_add_u32 v13, s10, v13
    v_add_f32 v136, v136, v140
    v_add_f32 v144, v144, v148
    v_add_f32 v138, v138, v142
    v_add_f32 v146, v146, v150
    v_add_f32 v136, v136, v144
    v_add_f32 v138, v138, v146
    v_and_b32 v16, 15, v0
    v_lshrrev_b32 v21, 5, v0
    v_permlane32_swap_b32 v136, v138
    v_add_f32 v136, v136, v138
    v_mov_b32 v138, v136
    v_lshl_add_u32 v16, v16, 1, v21
    s_lshl_b32 s12, s4, 7
    s_add_u32 s12, s12, 147456
    v_lshl_add_u32 v16, v16, 2, s12
    v_permlane16_swap_b32 v136, v138
    s_add_u32 s15, s10, 148480
    v_add_u32 v21, s15, v18
    v_add_f32 v136, v136, v138
    ds_write_b32 v16, v136
    ds_write_b128 v21, v[152:155]
    s_lshl2_add_u32 s8, s4, 42512
    v_mov_b32 v16, s8
    v_add_u32 v23, 32, v16
    buffer_load_dwordx4 v[96:99], v18, s[68:71], s79 offen offset:2048 sc1
    buffer_load_dwordx4 v[100:103], v18, s[68:71], s79 offen offset:3072 sc1
    buffer_load_dwordx4 v[104:107], v17, s[68:71], s79 offen sc1
    s_add_u32 s79, s76, 184320
    buffer_load_dwordx4 v[108:111], v18, s[68:71], s79 offen offset:0 sc1
    buffer_load_dwordx4 v[112:115], v18, s[68:71], s79 offen offset:1024 sc1
    buffer_load_dwordx4 v[116:119], v18, s[68:71], s79 offen offset:2048 sc1
    s_waitcnt lgkmcnt(0)
    s_barrier
    buffer_load_dwordx4 v[120:123], v18, s[68:71], s79 offen offset:3072 sc1
    buffer_load_dwordx4 v[124:127], v17, s[68:71], s79 offen sc1
    s_add_u32 m0, s82, 0
    s_add_u32 s79, s76, 40960
    buffer_load_dwordx4 v18, s[68:71], s79 offen offset:0 sc1 lds
    buffer_load_dwordx4 v18, s[68:71], s79 offen offset:1024 sc1 lds
    buffer_load_dwordx4 v18, s[68:71], s79 offen offset:2048 sc1 lds
    buffer_load_dwordx4 v18, s[68:71], s79 offen offset:3072 sc1 lds
    s_add_u32 m0, s82, 4096
    s_nop 0
    buffer_load_dwordx4 v17, s[68:71], s79 offen sc1 lds
    s_add_u32 m0, s82, 20480
    s_add_u32 s79, s76, 61440
    buffer_load_dwordx4 v18, s[68:71], s79 offen offset:0 sc1 lds
    buffer_load_dwordx4 v18, s[68:71], s79 offen offset:1024 sc1 lds
    buffer_load_dwordx4 v18, s[68:71], s79 offen offset:2048 sc1 lds
    buffer_load_dwordx4 v18, s[68:71], s79 offen offset:3072 sc1 lds
    s_add_u32 m0, s82, 24576
    s_nop 0
    buffer_load_dwordx4 v17, s[68:71], s79 offen sc1 lds
    s_add_u32 m0, s82, 40960
    s_add_u32 s79, s76, 81920
    buffer_load_dwordx4 v18, s[68:71], s79 offen offset:0 sc1 lds
    buffer_load_dwordx4 v18, s[68:71], s79 offen offset:1024 sc1 lds
    s_waitcnt vmcnt(4)
    s_cmp_ge_u32 s4, 2
    s_cbranch_scc1 L_p_21
    ds_write_b64 v218, v[216:217] offset:10496
    ds_write_b64 v223, v[216:217]
    ds_write_b64 v218, v[208:209] offset:32
    ds_write_b64 v218, v[224:225] offset:2656
    ds_write_b64 v218, v[226:227] offset:5280
    ds_write_b64 v218, v[228:229] offset:7904
    s_mov_b64 exec, 1
    ds_write_b32 v218, v230 offset:2652
    ds_write_b32 v218, v208 offset:5276
    ds_write_b64 v218, v[230:231] offset:7896
    s_mov_b64 exec, -1
    ds_write_b64 v218, v[232:233] offset:544
    ds_write_b64 v218, v[234:235] offset:3168
    ds_write_b64 v218, v[236:237] offset:5792
    ds_write_b64 v218, v[238:239] offset:8416
    s_branch L_p_22
L_p_21:
    ds_write_b128 v214, v[216:219] offset:2080
    ds_write_b128 v214, v[216:219] offset:7328
    ds_write_b128 v212, v[220:223] offset:1056
    ds_write_b128 v212, v[224:227] offset:3680
    ds_write_b128 v212, v[228:231] offset:6304
    ds_write_b128 v212, v[232:235] offset:8928
    ds_write_b16_d16_hi v213, v210 offset:2272
    ds_write_b16 v213, v211 offset:2432
    ds_write_b16_d16_hi v213, v210 offset:4894
    ds_write_b16 v213, v211 offset:5054
    ds_write_b16_d16_hi v213, v210 offset:7516
    ds_write_b16 v213, v211 offset:7676
    ds_write_b16_d16_hi v213, v210 offset:10138
    ds_write_b16 v213, v211 offset:10298
    s_mov_b64 exec, 1
    ds_write_b64 v215, v[236:237] offset:2080
    ds_write_b32 v215, v238 offset:2088
    ds_write_b64 v215, v[236:237] offset:4704
    ds_write_b32 v215, v236 offset:7328
    ds_write_b32 v215, v238 offset:7332
    ds_write_b32 v215, v236 offset:9952
    s_mov_b64 exec, -1
L_p_22:
    s_waitcnt vmcnt(20)
    ds_write_b128 v13, v[160:163] offset:11008
    ds_write_b128 v13, v[164:167] offset:11520
    ds_write_b32 v16, v22
    s_waitcnt vmcnt(4)
    buffer_load_dwordx4 v18, s[68:71], s79 offen offset:2048 sc1 lds
    s_waitcnt vmcnt(4)
    buffer_load_dwordx4 v18, s[68:71], s79 offen offset:3072 sc1 lds
    s_waitcnt vmcnt(4)
    s_add_u32 m0, s82, 45056
    s_nop 0
    buffer_load_dwordx4 v17, s[68:71], s79 offen sc1 lds
    s_waitcnt vmcnt(4)
    s_add_u32 m0, s82, 61440
    s_add_u32 s79, s76, 102400
    buffer_load_dwordx4 v18, s[68:71], s79 offen offset:0 sc1 lds
    s_waitcnt vmcnt(4)
    buffer_load_dwordx4 v18, s[68:71], s79 offen offset:1024 sc1 lds
    s_waitcnt vmcnt(4)
    buffer_load_dwordx4 v18, s[68:71], s79 offen offset:2048 sc1 lds
    s_waitcnt vmcnt(4)
    buffer_load_dwordx4 v18, s[68:71], s79 offen offset:3072 sc1 lds
    s_waitcnt vmcnt(4)
    s_add_u32 m0, s82, 65536
    s_nop 0
    buffer_load_dwordx4 v17, s[68:71], s79 offen sc1 lds
    s_waitcnt vmcnt(4)
    s_add_u32 m0, s82, 81920
    s_add_u32 s79, s76, 122880
    buffer_load_dwordx4 v18, s[68:71], s79 offen offset:0 sc1 lds
    s_waitcnt vmcnt(4)
    buffer_load_dwordx4 v18, s[68:71], s79 offen offset:1024 sc1 lds
    s_waitcnt vmcnt(4)
    buffer_load_dwordx4 v18, s[68:71], s79 offen offset:2048 sc1 lds
    s_waitcnt vmcnt(4)
    buffer_load_dwordx4 v18, s[68:71], s79 offen offset:3072 sc1 lds
    s_waitcnt vmcnt(4)
    s_add_u32 m0, s82, 86016
    s_nop 0
    buffer_load_dwordx4 v17, s[68:71], s79 offen sc1 lds
    ds_read_b32 v21, v23
    s_waitcnt lgkmcnt(0)
L_own_23:
    v_cmp_ne_u32 vcc, s95, v21
    s_cmp_eq_u64 vcc, 0
    s_cbranch_scc1 L_own_24
    s_add_u32 s89, s89, 1
    s_cmp_ge_u32 s89, 400000
    s_cbranch_scc1 L_own_24
    s_sleep 2
    ds_read_b32 v21, v23
    s_waitcnt lgkmcnt(0)
    s_branch L_own_23
L_own_24:
    s_sleep 10
L_g2:
    s_mov_b32 s56, s38
    s_mov_b32 s57, s39
    s_mov_b32 s58, 2621440
    s_mov_b32 s59, 0x20000
    s_add_u32 s60, s42, 12963840
    s_addc_u32 s61, s43, 0
    s_mov_b32 s62, 2703360
    s_mov_b32 s63, 0x20000
    buffer_load_dword v8, v20, s[84:87], s18 offen sc1
    s_waitcnt vmcnt(0)
L_g2c:
L_hf_25:
    v_cmp_ne_u32 vcc, s95, v8
    s_cmp_eq_u64 vcc, 0
    s_cbranch_scc1 L_hf_26
    s_add_u32 s89, s89, 1
    s_cmp_ge_u32 s89, 400000
    s_cbranch_scc1 L_hf_26
    s_sleep 6
    buffer_load_dword v8, v20, s[84:87], s18 offen sc1
    s_waitcnt vmcnt(0)
    s_branch L_hf_25
L_hf_26:
    s_lshl2_add_u32 s8, s4, 42592
    v_mov_b32 v16, s8
    v_mov_b32 v21, s95
    s_add_u32 s79, s77, 0
    buffer_load_dwordx4 v[132:135], v3, s[64:67], s79 offen sc1
    buffer_load_dwordx4 v[136:139], v4, s[64:67], s79 offen sc1
    buffer_load_dwordx4 v[140:143], v5, s[64:67], s79 offen sc1
    buffer_load_dwordx4 v[128:131], v2, s[64:67], s79 offen sc1
    s_add_u32 s79, s77, 16384
    buffer_load_dwordx4 v[148:151], v3, s[64:67], s79 offen sc1
    buffer_load_dwordx4 v[152:155], v4, s[64:67], s79 offen sc1
    buffer_load_dwordx4 v[156:159], v5, s[64:67], s79 offen sc1
    buffer_load_dwordx4 v[144:147], v2, s[64:67], s79 offen sc1
    s_add_u32 s79, s77, 32768
    buffer_load_dwordx4 v[164:167], v3, s[64:67], s79 offen sc1
    buffer_load_dwordx4 v[168:171], v4, s[64:67], s79 offen sc1
    buffer_load_dwordx4 v[172:175], v5, s[64:67], s79 offen sc1
    buffer_load_dwordx4 v[160:163], v2, s[64:67], s79 offen sc1
    s_waitcnt vmcnt(11)
    v_mfma_f32_16x16x32_bf16 v[196:199], v[28:31], v[132:135], 0
    v_mfma_f32_16x16x32_bf16 v[200:203], v[32:35], v[132:135], 0
    v_mfma_f32_16x16x32_bf16 v[204:207], v[36:39], v[132:135], 0
    v_mfma_f32_16x16x32_bf16 v[208:211], v[40:43], v[132:135], 0
    v_mfma_f32_16x16x32_bf16 v[212:215], v[44:47], v[132:135], 0
    s_waitcnt vmcnt(10)
    v_mfma_f32_16x16x32_bf16 v[232:235], v[44:47], v[136:139], 0
    s_add_u32 s79, s77, 49152
    buffer_load_dwordx4 v[132:135], v3, s[64:67], s79 offen sc1
    v_mfma_f32_16x16x32_bf16 v[228:231], v[40:43], v[136:139], 0
    v_mfma_f32_16x16x32_bf16 v[224:227], v[36:39], v[136:139], 0
    v_mfma_f32_16x16x32_bf16 v[220:223], v[32:35], v[136:139], 0
    v_mfma_f32_16x16x32_bf16 v[216:219], v[28:31], v[136:139], 0
    s_waitcnt vmcnt(10)
    v_mfma_f32_16x16x32_bf16 v[236:239], v[28:31], v[140:143], 0
    buffer_load_dwordx4 v[136:139], v4, s[64:67], s79 offen sc1
    v_mfma_f32_16x16x32_bf16 v[240:243], v[32:35], v[140:143], 0
    v_mfma_f32_16x16x32_bf16 v[244:247], v[36:39], v[140:143], 0
    v_mfma_f32_16x16x32_bf16 v[248:251], v[40:43], v[140:143], 0
    v_mfma_f32_16x16x32_bf16 v[252:255], v[44:47], v[140:143], 0
    s_waitcnt vmcnt(10)
    v_mfma_f32_16x16x32_bf16 v[192:195], v[44:47], v[128:131], v[192:195]
    buffer_load_dwordx4 v[140:143], v5, s[64:67], s79 offen sc1
    v_mfma_f32_16x16x32_bf16 v[188:191], v[40:43], v[128:131], v[188:191]
    v_mfma_f32_16x16x32_bf16 v[184:187], v[36:39], v[128:131], v[184:187]
    v_mfma_f32_16x16x32_bf16 v[180:183], v[32:35], v[128:131], v[180:183]
    v_mfma_f32_16x16x32_bf16 v[176:179], v[28:31], v[128:131], v[176:179]
    buffer_load_dwordx4 v[128:131], v2, s[64:67], s79 offen sc1
    s_waitcnt vmcnt(8)
    v_mfma_f32_16x16x32_bf16 v[196:199], v[48:51], v[148:151], v[196:199]
    ds_read_b128 v[28:31], v6 offset:0
    v_mfma_f32_16x16x32_bf16 v[200:203], v[52:55], v[148:151], v[200:203]
    ds_read_b128 v[32:35], v6 offset:1024
    v_mfma_f32_16x16x32_bf16 v[204:207], v[56:59], v[148:151], v[204:207]
    ds_read_b128 v[36:39], v6 offset:2048
    v_mfma_f32_16x16x32_bf16 v[208:211], v[60:63], v[148:151], v[208:211]
    ds_read_b128 v[40:43], v6 offset:3072
    v_mfma_f32_16x16x32_bf16 v[212:215], v[64:67], v[148:151], v[212:215]
    ds_read_b128 v[44:47], v6 offset:4096
    v_mfma_f32_16x16x32_bf16 v[232:235], v[64:67], v[152:155], v[232:235]
    s_add_u32 s79, s77, 65536
    buffer_load_dwordx4 v[148:151], v3, s[64:67], s79 offen sc1
    v_mfma_f32_16x16x32_bf16 v[228:231], v[60:63], v[152:155], v[228:231]
    v_mfma_f32_16x16x32_bf16 v[224:227], v[56:59], v[152:155], v[224:227]
    v_mfma_f32_16x16x32_bf16 v[220:223], v[52:55], v[152:155], v[220:223]
    v_mfma_f32_16x16x32_bf16 v[216:219], v[48:51], v[152:155], v[216:219]
    v_mfma_f32_16x16x32_bf16 v[236:239], v[48:51], v[156:159], v[236:239]
    buffer_load_dwordx4 v[152:155], v4, s[64:67], s79 offen sc1
    v_mfma_f32_16x16x32_bf16 v[240:243], v[52:55], v[156:159], v[240:243]
    v_mfma_f32_16x16x32_bf16 v[244:247], v[56:59], v[156:159], v[244:247]
    v_mfma_f32_16x16x32_bf16 v[248:251], v[60:63], v[156:159], v[248:251]
    v_mfma_f32_16x16x32_bf16 v[252:255], v[64:67], v[156:159], v[252:255]
    v_mfma_f32_16x16x32_bf16 v[192:195], v[64:67], v[144:147], v[192:195]
    buffer_load_dwordx4 v[156:159], v5, s[64:67], s79 offen sc1
    v_mfma_f32_16x16x32_bf16 v[188:191], v[60:63], v[144:147], v[188:191]
    v_mfma_f32_16x16x32_bf16 v[184:187], v[56:59], v[144:147], v[184:187]
    v_mfma_f32_16x16x32_bf16 v[180:183], v[52:55], v[144:147], v[180:183]
    v_mfma_f32_16x16x32_bf16 v[176:179], v[48:51], v[144:147], v[176:179]
    buffer_load_dwordx4 v[144:147], v2, s[64:67], s79 offen sc1
    s_waitcnt lgkmcnt(0)
    s_waitcnt vmcnt(8)
    v_mfma_f32_16x16x32_bf16 v[196:199], v[28:31], v[164:167], v[196:199]
    ds_read_b128 v[48:51], v6 offset:20480
    v_mfma_f32_16x16x32_bf16 v[200:203], v[32:35], v[164:167], v[200:203]
    ds_read_b128 v[52:55], v6 offset:21504
    v_mfma_f32_16x16x32_bf16 v[204:207], v[36:39], v[164:167], v[204:207]
    ds_read_b128 v[56:59], v6 offset:22528
    v_mfma_f32_16x16x32_bf16 v[208:211], v[40:43], v[164:167], v[208:211]
    ds_read_b128 v[60:63], v6 offset:23552
    v_mfma_f32_16x16x32_bf16 v[212:215], v[44:47], v[164:167], v[212:215]
    ds_read_b128 v[64:67], v6 offset:24576
    v_mfma_f32_16x16x32_bf16 v[232:235], v[44:47], v[168:171], v[232:235]
    s_add_u32 s79, s77, 81920
    buffer_load_dwordx4 v[164:167], v3, s[64:67], s79 offen sc1
    v_mfma_f32_16x16x32_bf16 v[228:231], v[40:43], v[168:171], v[228:231]
    v_mfma_f32_16x16x32_bf16 v[224:227], v[36:39], v[168:171], v[224:227]
    v_mfma_f32_16x16x32_bf16 v[220:223], v[32:35], v[168:171], v[220:223]
    v_mfma_f32_16x16x32_bf16 v[216:219], v[28:31], v[168:171], v[216:219]
    v_mfma_f32_16x16x32_bf16 v[236:239], v[28:31], v[172:175], v[236:239]
    buffer_load_dwordx4 v[168:171], v4, s[64:67], s79 offen sc1
    v_mfma_f32_16x16x32_bf16 v[240:243], v[32:35], v[172:175], v[240:243]
    v_mfma_f32_16x16x32_bf16 v[244:247], v[36:39], v[172:175], v[244:247]
    v_mfma_f32_16x16x32_bf16 v[248:251], v[40:43], v[172:175], v[248:251]
    v_mfma_f32_16x16x32_bf16 v[252:255], v[44:47], v[172:175], v[252:255]
    v_mfma_f32_16x16x32_bf16 v[192:195], v[44:47], v[160:163], v[192:195]
    buffer_load_dwordx4 v[172:175], v5, s[64:67], s79 offen sc1
    v_mfma_f32_16x16x32_bf16 v[188:191], v[40:43], v[160:163], v[188:191]
    v_mfma_f32_16x16x32_bf16 v[184:187], v[36:39], v[160:163], v[184:187]
    v_mfma_f32_16x16x32_bf16 v[180:183], v[32:35], v[160:163], v[180:183]
    v_mfma_f32_16x16x32_bf16 v[176:179], v[28:31], v[160:163], v[176:179]
    buffer_load_dwordx4 v[160:163], v2, s[64:67], s79 offen sc1
    s_waitcnt lgkmcnt(0)
    s_waitcnt vmcnt(8)
    v_mfma_f32_16x16x32_bf16 v[196:199], v[48:51], v[132:135], v[196:199]
    ds_read_b128 v[28:31], v6 offset:40960
    v_mfma_f32_16x16x32_bf16 v[200:203], v[52:55], v[132:135], v[200:203]
    ds_read_b128 v[32:35], v6 offset:41984
    v_mfma_f32_16x16x32_bf16 v[204:207], v[56:59], v[132:135], v[204:207]
    ds_read_b128 v[36:39], v6 offset:43008
    v_mfma_f32_16x16x32_bf16 v[208:211], v[60:63], v[132:135], v[208:211]
    ds_read_b128 v[40:43], v6 offset:44032
    v_mfma_f32_16x16x32_bf16 v[212:215], v[64:67], v[132:135], v[212:215]
    ds_read_b128 v[44:47], v6 offset:45056
    v_mfma_f32_16x16x32_bf16 v[232:235], v[64:67], v[136:139], v[232:235]
    s_add_u32 s79, s77, 98304
    buffer_load_dwordx4 v[132:135], v3, s[64:67], s79 offen sc1
    v_mfma_f32_16x16x32_bf16 v[228:231], v[60:63], v[136:139], v[228:231]
    v_mfma_f32_16x16x32_bf16 v[224:227], v[56:59], v[136:139], v[224:227]
    v_mfma_f32_16x16x32_bf16 v[220:223], v[52:55], v[136:139], v[220:223]
    v_mfma_f32_16x16x32_bf16 v[216:219], v[48:51], v[136:139], v[216:219]
    v_mfma_f32_16x16x32_bf16 v[236:239], v[48:51], v[140:143], v[236:239]
    buffer_load_dwordx4 v[136:139], v4, s[64:67], s79 offen sc1
    v_mfma_f32_16x16x32_bf16 v[240:243], v[52:55], v[140:143], v[240:243]
    v_mfma_f32_16x16x32_bf16 v[244:247], v[56:59], v[140:143], v[244:247]
    v_mfma_f32_16x16x32_bf16 v[248:251], v[60:63], v[140:143], v[248:251]
    v_mfma_f32_16x16x32_bf16 v[252:255], v[64:67], v[140:143], v[252:255]
    v_mfma_f32_16x16x32_bf16 v[192:195], v[64:67], v[128:131], v[192:195]
    buffer_load_dwordx4 v[140:143], v5, s[64:67], s79 offen sc1
    v_mfma_f32_16x16x32_bf16 v[188:191], v[60:63], v[128:131], v[188:191]
    v_mfma_f32_16x16x32_bf16 v[184:187], v[56:59], v[128:131], v[184:187]
    v_mfma_f32_16x16x32_bf16 v[180:183], v[52:55], v[128:131], v[180:183]
    v_mfma_f32_16x16x32_bf16 v[176:179], v[48:51], v[128:131], v[176:179]
    buffer_load_dwordx4 v[128:131], v2, s[64:67], s79 offen sc1
    s_waitcnt lgkmcnt(0)
    s_waitcnt vmcnt(8)
    v_mfma_f32_16x16x32_bf16 v[196:199], v[28:31], v[148:151], v[196:199]
    ds_read_b128 v[48:51], v7 offset:0
    v_mfma_f32_16x16x32_bf16 v[200:203], v[32:35], v[148:151], v[200:203]
    ds_read_b128 v[52:55], v7 offset:1024
    v_mfma_f32_16x16x32_bf16 v[204:207], v[36:39], v[148:151], v[204:207]
    ds_read_b128 v[56:59], v7 offset:2048
    v_mfma_f32_16x16x32_bf16 v[208:211], v[40:43], v[148:151], v[208:211]
    ds_read_b128 v[60:63], v7 offset:3072
    v_mfma_f32_16x16x32_bf16 v[212:215], v[44:47], v[148:151], v[212:215]
    ds_read_b128 v[64:67], v7 offset:4096
    v_mfma_f32_16x16x32_bf16 v[232:235], v[44:47], v[152:155], v[232:235]
    s_add_u32 s79, s77, 114688
    buffer_load_dwordx4 v[148:151], v3, s[64:67], s79 offen sc1
    v_mfma_f32_16x16x32_bf16 v[228:231], v[40:43], v[152:155], v[228:231]
    v_mfma_f32_16x16x32_bf16 v[224:227], v[36:39], v[152:155], v[224:227]
    v_mfma_f32_16x16x32_bf16 v[220:223], v[32:35], v[152:155], v[220:223]
    v_mfma_f32_16x16x32_bf16 v[216:219], v[28:31], v[152:155], v[216:219]
    v_mfma_f32_16x16x32_bf16 v[236:239], v[28:31], v[156:159], v[236:239]
    buffer_load_dwordx4 v[152:155], v4, s[64:67], s79 offen sc1
    v_mfma_f32_16x16x32_bf16 v[240:243], v[32:35], v[156:159], v[240:243]
    v_mfma_f32_16x16x32_bf16 v[244:247], v[36:39], v[156:159], v[244:247]
    v_mfma_f32_16x16x32_bf16 v[248:251], v[40:43], v[156:159], v[248:251]
    v_mfma_f32_16x16x32_bf16 v[252:255], v[44:47], v[156:159], v[252:255]
    v_mfma_f32_16x16x32_bf16 v[192:195], v[44:47], v[144:147], v[192:195]
    buffer_load_dwordx4 v[156:159], v5, s[64:67], s79 offen sc1
    v_mfma_f32_16x16x32_bf16 v[188:191], v[40:43], v[144:147], v[188:191]
    v_mfma_f32_16x16x32_bf16 v[184:187], v[36:39], v[144:147], v[184:187]
    v_mfma_f32_16x16x32_bf16 v[180:183], v[32:35], v[144:147], v[180:183]
    v_mfma_f32_16x16x32_bf16 v[176:179], v[28:31], v[144:147], v[176:179]
    buffer_load_dwordx4 v[144:147], v2, s[64:67], s79 offen sc1
    s_waitcnt lgkmcnt(0)
    s_waitcnt vmcnt(8)
    v_mfma_f32_16x16x32_bf16 v[196:199], v[48:51], v[164:167], v[196:199]
    ds_read_b128 v[28:31], v7 offset:20480
    v_mfma_f32_16x16x32_bf16 v[200:203], v[52:55], v[164:167], v[200:203]
    ds_read_b128 v[32:35], v7 offset:21504
    v_mfma_f32_16x16x32_bf16 v[204:207], v[56:59], v[164:167], v[204:207]
    ds_read_b128 v[36:39], v7 offset:22528
    v_mfma_f32_16x16x32_bf16 v[208:211], v[60:63], v[164:167], v[208:211]
    ds_read_b128 v[40:43], v7 offset:23552
    v_mfma_f32_16x16x32_bf16 v[212:215], v[64:67], v[164:167], v[212:215]
    ds_read_b128 v[44:47], v7 offset:24576
    v_mfma_f32_16x16x32_bf16 v[232:235], v[64:67], v[168:171], v[232:235]
    s_add_u32 s79, s77, 131072
    buffer_load_dwordx4 v[164:167], v3, s[64:67], s79 offen sc1
    v_mfma_f32_16x16x32_bf16 v[228:231], v[60:63], v[168:171], v[228:231]
    v_mfma_f32_16x16x32_bf16 v[224:227], v[56:59], v[168:171], v[224:227]
    v_mfma_f32_16x16x32_bf16 v[220:223], v[52:55], v[168:171], v[220:223]
    v_mfma_f32_16x16x32_bf16 v[216:219], v[48:51], v[168:171], v[216:219]
    v_mfma_f32_16x16x32_bf16 v[236:239], v[48:51], v[172:175], v[236:239]
    buffer_load_dwordx4 v[168:171], v4, s[64:67], s79 offen sc1
    v_mfma_f32_16x16x32_bf16 v[240:243], v[52:55], v[172:175], v[240:243]
    v_mfma_f32_16x16x32_bf16 v[244:247], v[56:59], v[172:175], v[244:247]
    v_mfma_f32_16x16x32_bf16 v[248:251], v[60:63], v[172:175], v[248:251]
    v_mfma_f32_16x16x32_bf16 v[252:255], v[64:67], v[172:175], v[252:255]
    v_mfma_f32_16x16x32_bf16 v[192:195], v[64:67], v[160:163], v[192:195]
    buffer_load_dwordx4 v[172:175], v5, s[64:67], s79 offen sc1
    v_mfma_f32_16x16x32_bf16 v[188:191], v[60:63], v[160:163], v[188:191]
    v_mfma_f32_16x16x32_bf16 v[184:187], v[56:59], v[160:163], v[184:187]
    v_mfma_f32_16x16x32_bf16 v[180:183], v[52:55], v[160:163], v[180:183]
    v_mfma_f32_16x16x32_bf16 v[176:179], v[48:51], v[160:163], v[176:179]
    buffer_load_dwordx4 v[160:163], v2, s[64:67], s79 offen sc1
    s_waitcnt lgkmcnt(0)
    ds_write_b32 v16, v21
    s_waitcnt vmcnt(8)
    v_mfma_f32_16x16x32_bf16 v[196:199], v[28:31], v[132:135], v[196:199]
    v_mfma_f32_16x16x32_bf16 v[200:203], v[32:35], v[132:135], v[200:203]
    v_mfma_f32_16x16x32_bf16 v[204:207], v[36:39], v[132:135], v[204:207]
    v_mfma_f32_16x16x32_bf16 v[208:211], v[40:43], v[132:135], v[208:211]
    v_mfma_f32_16x16x32_bf16 v[212:215], v[44:47], v[132:135], v[212:215]
    v_mfma_f32_16x16x32_bf16 v[232:235], v[44:47], v[136:139], v[232:235]
    s_add_u32 s79, s77, 147456
    buffer_load_dwordx4 v[132:135], v3, s[64:67], s79 offen sc1
    v_mfma_f32_16x16x32_bf16 v[228:231], v[40:43], v[136:139], v[228:231]
    v_mfma_f32_16x16x32_bf16 v[224:227], v[36:39], v[136:139], v[224:227]
    v_mfma_f32_16x16x32_bf16 v[220:223], v[32:35], v[136:139], v[220:223]
    v_mfma_f32_16x16x32_bf16 v[216:219], v[28:31], v[136:139], v[216:219]
    v_mfma_f32_16x16x32_bf16 v[236:239], v[28:31], v[140:143], v[236:239]
    buffer_load_dwordx4 v[136:139], v4, s[64:67], s79 offen sc1
    v_mfma_f32_16x16x32_bf16 v[240:243], v[32:35], v[140:143], v[240:243]
    v_mfma_f32_16x16x32_bf16 v[244:247], v[36:39], v[140:143], v[244:247]
    v_mfma_f32_16x16x32_bf16 v[248:251], v[40:43], v[140:143], v[248:251]
    v_mfma_f32_16x16x32_bf16 v[252:255], v[44:47], v[140:143], v[252:255]
    v_mfma_f32_16x16x32_bf16 v[192:195], v[44:47], v[128:131], v[192:195]
    buffer_load_dwordx4 v[140:143], v5, s[64:67], s79 offen sc1
    v_mfma_f32_16x16x32_bf16 v[188:191], v[40:43], v[128:131], v[188:191]
    v_mfma_f32_16x16x32_bf16 v[184:187], v[36:39], v[128:131], v[184:187]
    v_mfma_f32_16x16x32_bf16 v[180:183], v[32:35], v[128:131], v[180:183]
    v_mfma_f32_16x16x32_bf16 v[176:179], v[28:31], v[128:131], v[176:179]
    buffer_load_dwordx4 v[128:131], v2, s[64:67], s79 offen sc1
    s_waitcnt vmcnt(8)
    v_mfma_f32_16x16x32_bf16 v[196:199], v[68:71], v[148:151], v[196:199]
    v_mfma_f32_16x16x32_bf16 v[200:203], v[72:75], v[148:151], v[200:203]
    v_mfma_f32_16x16x32_bf16 v[204:207], v[76:79], v[148:151], v[204:207]
    v_mfma_f32_16x16x32_bf16 v[208:211], v[80:83], v[148:151], v[208:211]
    v_mfma_f32_16x16x32_bf16 v[212:215], v[84:87], v[148:151], v[212:215]
    v_mfma_f32_16x16x32_bf16 v[232:235], v[84:87], v[152:155], v[232:235]
    s_add_u32 s79, s77, 163840
    buffer_load_dwordx4 v[148:151], v3, s[64:67], s79 offen sc1
    v_mfma_f32_16x16x32_bf16 v[228:231], v[80:83], v[152:155], v[228:231]
    v_mfma_f32_16x16x32_bf16 v[224:227], v[76:79], v[152:155], v[224:227]
    v_mfma_f32_16x16x32_bf16 v[220:223], v[72:75], v[152:155], v[220:223]
    v_mfma_f32_16x16x32_bf16 v[216:219], v[68:71], v[152:155], v[216:219]
    v_mfma_f32_16x16x32_bf16 v[236:239], v[68:71], v[156:159], v[236:239]
    buffer_load_dwordx4 v[152:155], v4, s[64:67], s79 offen sc1
    v_mfma_f32_16x16x32_bf16 v[240:243], v[72:75], v[156:159], v[240:243]
    v_mfma_f32_16x16x32_bf16 v[244:247], v[76:79], v[156:159], v[244:247]
    v_mfma_f32_16x16x32_bf16 v[248:251], v[80:83], v[156:159], v[248:251]
    v_mfma_f32_16x16x32_bf16 v[252:255], v[84:87], v[156:159], v[252:255]
    v_mfma_f32_16x16x32_bf16 v[192:195], v[84:87], v[144:147], v[192:195]
    buffer_load_dwordx4 v[156:159], v5, s[64:67], s79 offen sc1
    v_mfma_f32_16x16x32_bf16 v[188:191], v[80:83], v[144:147], v[188:191]
    v_mfma_f32_16x16x32_bf16 v[184:187], v[76:79], v[144:147], v[184:187]
    v_mfma_f32_16x16x32_bf16 v[180:183], v[72:75], v[144:147], v[180:183]
    v_mfma_f32_16x16x32_bf16 v[176:179], v[68:71], v[144:147], v[176:179]
    buffer_load_dwordx4 v[144:147], v2, s[64:67], s79 offen sc1
    s_waitcnt vmcnt(8)
    v_mfma_f32_16x16x32_bf16 v[196:199], v[88:91], v[164:167], v[196:199]
    v_mfma_f32_16x16x32_bf16 v[200:203], v[92:95], v[164:167], v[200:203]
    v_mfma_f32_16x16x32_bf16 v[204:207], v[96:99], v[164:167], v[204:207]
    s_add_u32 s75, s76, 266240
    s_and_b32 s0, s4, 2
    s_mul_i32 s0, s0, 5120
    s_sub_u32 s75, s75, s0
    buffer_load_dwordx4 v[68:71], v18, s[68:71], s75 offen offset:0 sc1
    v_mfma_f32_16x16x32_bf16 v[208:211], v[100:103], v[164:167], v[208:211]
    v_mfma_f32_16x16x32_bf16 v[212:215], v[104:107], v[164:167], v[212:215]
    v_mfma_f32_16x16x32_bf16 v[232:235], v[104:107], v[168:171], v[232:235]
    s_add_u32 s79, s77, 180224
    buffer_load_dwordx4 v[164:167], v3, s[64:67], s79 offen sc1
    v_mfma_f32_16x16x32_bf16 v[228:231], v[100:103], v[168:171], v[228:231]
    v_mfma_f32_16x16x32_bf16 v[224:227], v[96:99], v[168:171], v[224:227]
    buffer_load_dwordx4 v[72:75], v18, s[68:71], s75 offen offset:1024 sc1
    v_mfma_f32_16x16x32_bf16 v[220:223], v[92:95], v[168:171], v[220:223]
    v_mfma_f32_16x16x32_bf16 v[216:219], v[88:91], v[168:171], v[216:219]
    v_mfma_f32_16x16x32_bf16 v[236:239], v[88:91], v[172:175], v[236:239]
    buffer_load_dwordx4 v[168:171], v4, s[64:67], s79 offen sc1
    v_mfma_f32_16x16x32_bf16 v[240:243], v[92:95], v[172:175], v[240:243]
    v_mfma_f32_16x16x32_bf16 v[244:247], v[96:99], v[172:175], v[244:247]
    v_mfma_f32_16x16x32_bf16 v[248:251], v[100:103], v[172:175], v[248:251]
    v_mfma_f32_16x16x32_bf16 v[252:255], v[104:107], v[172:175], v[252:255]
    v_mfma_f32_16x16x32_bf16 v[192:195], v[104:107], v[160:163], v[192:195]
    ds_read_b32 v21, v16 offset:16
    buffer_load_dwordx4 v[172:175], v5, s[64:67], s79 offen sc1
    v_mfma_f32_16x16x32_bf16 v[188:191], v[100:103], v[160:163], v[188:191]
    v_mfma_f32_16x16x32_bf16 v[184:187], v[96:99], v[160:163], v[184:187]
    v_mfma_f32_16x16x32_bf16 v[180:183], v[92:95], v[160:163], v[180:183]
    v_mfma_f32_16x16x32_bf16 v[176:179], v[88:91], v[160:163], v[176:179]
    buffer_load_dwordx4 v[160:163], v2, s[64:67], s79 offen sc1
    s_waitcnt lgkmcnt(0)
L_car_27:
    v_cmp_ne_u32 vcc, s95, v21
    s_cmp_eq_u64 vcc, 0
    s_cbranch_scc1 L_car_28
    s_add_u32 s89, s89, 1
    s_cmp_ge_u32 s89, 400000
    s_cbranch_scc1 L_car_28
    s_sleep 1
    ds_read_b32 v21, v16 offset:16
    s_waitcnt lgkmcnt(0)
    s_branch L_car_27
L_car_28:
    s_waitcnt vmcnt(10)
    v_mfma_f32_16x16x32_bf16 v[196:199], v[108:111], v[132:135], v[196:199]
    ds_read_b128 v[48:51], v6 offset:0
    v_mfma_f32_16x16x32_bf16 v[200:203], v[112:115], v[132:135], v[200:203]
    ds_read_b128 v[52:55], v6 offset:1024
    v_mfma_f32_16x16x32_bf16 v[204:207], v[116:119], v[132:135], v[204:207]
    ds_read_b128 v[56:59], v6 offset:2048
    buffer_load_dwordx4 v[76:79], v18, s[68:71], s75 offen offset:2048 sc1
    v_mfma_f32_16x16x32_bf16 v[208:211], v[120:123], v[132:135], v[208:211]
    ds_read_b128 v[60:63], v6 offset:3072
    v_mfma_f32_16x16x32_bf16 v[212:215], v[124:127], v[132:135], v[212:215]
    ds_read_b128 v[64:67], v6 offset:4096
    v_mfma_f32_16x16x32_bf16 v[232:235], v[124:127], v[136:139], v[232:235]
    s_add_u32 s79, s77, 196608
    buffer_load_dwordx4 v[132:135], v3, s[64:67], s79 offen sc1
    v_mfma_f32_16x16x32_bf16 v[228:231], v[120:123], v[136:139], v[228:231]
    v_mfma_f32_16x16x32_bf16 v[224:227], v[116:119], v[136:139], v[224:227]
    buffer_load_dwordx4 v[80:83], v18, s[68:71], s75 offen offset:3072 sc1
    v_mfma_f32_16x16x32_bf16 v[220:223], v[112:115], v[136:139], v[220:223]
    v_mfma_f32_16x16x32_bf16 v[216:219], v[108:111], v[136:139], v[216:219]
    v_mfma_f32_16x16x32_bf16 v[236:239], v[108:111], v[140:143], v[236:239]
    buffer_load_dwordx4 v[136:139], v4, s[64:67], s79 offen sc1
    v_mfma_f32_16x16x32_bf16 v[240:243], v[112:115], v[140:143], v[240:243]
    v_mfma_f32_16x16x32_bf16 v[244:247], v[116:119], v[140:143], v[244:247]
    buffer_load_dwordx4 v[84:87], v17, s[68:71], s75 offen sc1
    v_mfma_f32_16x16x32_bf16 v[248:251], v[120:123], v[140:143], v[248:251]
    v_mfma_f32_16x16x32_bf16 v[252:255], v[124:127], v[140:143], v[252:255]
    v_mfma_f32_16x16x32_bf16 v[192:195], v[124:127], v[128:131], v[192:195]
    buffer_load_dwordx4 v[140:143], v5, s[64:67], s79 offen sc1
    v_mfma_f32_16x16x32_bf16 v[188:191], v[120:123], v[128:131], v[188:191]
    v_mfma_f32_16x16x32_bf16 v[184:187], v[116:119], v[128:131], v[184:187]
    v_mfma_f32_16x16x32_bf16 v[180:183], v[112:115], v[128:131], v[180:183]
    v_mfma_f32_16x16x32_bf16 v[176:179], v[108:111], v[128:131], v[176:179]
    buffer_load_dwordx4 v[128:131], v2, s[64:67], s79 offen sc1
    s_waitcnt lgkmcnt(0)
    s_waitcnt vmcnt(13)
    v_mfma_f32_16x16x32_bf16 v[196:199], v[48:51], v[148:151], v[196:199]
    ds_read_b128 v[28:31], v6 offset:20480
    v_mfma_f32_16x16x32_bf16 v[200:203], v[52:55], v[148:151], v[200:203]
    ds_read_b128 v[32:35], v6 offset:21504
    v_mfma_f32_16x16x32_bf16 v[204:207], v[56:59], v[148:151], v[204:207]
    ds_read_b128 v[36:39], v6 offset:22528
    v_mfma_f32_16x16x32_bf16 v[208:211], v[60:63], v[148:151], v[208:211]
    ds_read_b128 v[40:43], v6 offset:23552
    v_mfma_f32_16x16x32_bf16 v[212:215], v[64:67], v[148:151], v[212:215]
    ds_read_b128 v[44:47], v6 offset:24576
    v_mfma_f32_16x16x32_bf16 v[232:235], v[64:67], v[152:155], v[232:235]
    ds_read_b128 v[88:91], v6 offset:40960
    s_add_u32 s79, s77, 212992
    s_and_b32 s0, s4, 2
    s_lshl_b32 s0, s0, 12
    s_sub_u32 s79, s79, s0
    buffer_load_dwordx4 v[148:151], v3, s[64:67], s79 offen sc1
    v_mfma_f32_16x16x32_bf16 v[228:231], v[60:63], v[152:155], v[228:231]
    ds_read_b128 v[92:95], v6 offset:41984
    v_mfma_f32_16x16x32_bf16 v[224:227], v[56:59], v[152:155], v[224:227]
    ds_read_b128 v[96:99], v6 offset:43008
    v_mfma_f32_16x16x32_bf16 v[220:223], v[52:55], v[152:155], v[220:223]
    ds_read_b128 v[100:103], v6 offset:44032
    v_mfma_f32_16x16x32_bf16 v[216:219], v[48:51], v[152:155], v[216:219]
    ds_read_b128 v[104:107], v6 offset:45056
    v_mfma_f32_16x16x32_bf16 v[236:239], v[48:51], v[156:159], v[236:239]
    v_mfma_f32_16x16x32_bf16 v[240:243], v[52:55], v[156:159], v[240:243]
    v_mfma_f32_16x16x32_bf16 v[244:247], v[56:59], v[156:159], v[244:247]
    v_mfma_f32_16x16x32_bf16 v[248:251], v[60:63], v[156:159], v[248:251]
    v_mfma_f32_16x16x32_bf16 v[252:255], v[64:67], v[156:159], v[252:255]
    v_mfma_f32_16x16x32_bf16 v[192:195], v[64:67], v[144:147], v[192:195]
    v_mfma_f32_16x16x32_bf16 v[188:191], v[60:63], v[144:147], v[188:191]
    v_mfma_f32_16x16x32_bf16 v[184:187], v[56:59], v[144:147], v[184:187]
    v_mfma_f32_16x16x32_bf16 v[180:183], v[52:55], v[144:147], v[180:183]
    v_mfma_f32_16x16x32_bf16 v[176:179], v[48:51], v[144:147], v[176:179]
    buffer_load_dwordx4 v[144:147], v2, s[64:67], s79 offen sc1
    buffer_load_dword v8, v9, s[84:87], s19 offen sc1
    s_waitcnt lgkmcnt(0)
    s_waitcnt vmcnt(14)
    v_mfma_f32_16x16x32_bf16 v[196:199], v[28:31], v[164:167], v[196:199]
    v_mfma_f32_16x16x32_bf16 v[200:203], v[32:35], v[164:167], v[200:203]
    v_mfma_f32_16x16x32_bf16 v[204:207], v[36:39], v[164:167], v[204:207]
    v_mfma_f32_16x16x32_bf16 v[208:211], v[40:43], v[164:167], v[208:211]
    v_mfma_f32_16x16x32_bf16 v[212:215], v[44:47], v[164:167], v[212:215]
    s_waitcnt vmcnt(8)
    v_mfma_f32_16x16x32_bf16 v[196:199], v[88:91], v[132:135], v[196:199]
    v_mfma_f32_16x16x32_bf16 v[200:203], v[92:95], v[132:135], v[200:203]
    v_mfma_f32_16x16x32_bf16 v[204:207], v[96:99], v[132:135], v[204:207]
    v_mfma_f32_16x16x32_bf16 v[208:211], v[100:103], v[132:135], v[208:211]
    v_mfma_f32_16x16x32_bf16 v[212:215], v[104:107], v[132:135], v[212:215]
    s_waitcnt vmcnt(2)
    v_mfma_f32_16x16x32_bf16 v[196:199], v[68:71], v[148:151], v[196:199]
    v_mfma_f32_16x16x32_bf16 v[200:203], v[72:75], v[148:151], v[200:203]
    v_mfma_f32_16x16x32_bf16 v[204:207], v[76:79], v[148:151], v[204:207]
    v_mfma_f32_16x16x32_bf16 v[208:211], v[80:83], v[148:151], v[208:211]
    v_mfma_f32_16x16x32_bf16 v[212:215], v[84:87], v[148:151], v[212:215]
    s_waitcnt vmcnt(12)
    v_mfma_f32_16x16x32_bf16 v[216:219], v[28:31], v[168:171], v[216:219]
    v_mfma_f32_16x16x32_bf16 v[220:223], v[32:35], v[168:171], v[220:223]
    v_mfma_f32_16x16x32_bf16 v[224:227], v[36:39], v[168:171], v[224:227]
    v_mfma_f32_16x16x32_bf16 v[228:231], v[40:43], v[168:171], v[228:231]
    ds_write_b128 v6, v[196:199] offset:0
    v_mfma_f32_16x16x32_bf16 v[232:235], v[44:47], v[168:171], v[232:235]
    s_waitcnt vmcnt(6)
    v_mfma_f32_16x16x32_bf16 v[216:219], v[88:91], v[136:139], v[216:219]
    ds_write_b128 v6, v[200:203] offset:1024
    v_mfma_f32_16x16x32_bf16 v[220:223], v[92:95], v[136:139], v[220:223]
    v_mfma_f32_16x16x32_bf16 v[224:227], v[96:99], v[136:139], v[224:227]
    ds_write_b128 v6, v[204:207] offset:2048
    v_mfma_f32_16x16x32_bf16 v[228:231], v[100:103], v[136:139], v[228:231]
    v_mfma_f32_16x16x32_bf16 v[232:235], v[104:107], v[136:139], v[232:235]
    ds_write_b128 v6, v[208:211] offset:3072
    s_waitcnt vmcnt(0)
L_yf_29:
    v_cmp_ne_u32 vcc, s95, v8
    s_cmp_eq_u64 vcc, 0
    s_cbranch_scc1 L_yf_30
    s_add_u32 s89, s89, 1
    s_cmp_ge_u32 s89, 400000
    s_cbranch_scc1 L_yf_30
    s_sleep 6
    buffer_load_dword v8, v9, s[84:87], s19 offen sc1
    s_waitcnt vmcnt(0)
    s_branch L_yf_29
L_yf_30:
    s_add_u32 m0, s82, 61440
    s_nop 0
    buffer_load_dwordx4 v14, s[60:63], s21 offen sc1 lds
    s_add_u32 m0, s82, 62464
    s_add_u32 s21, s21, 33792
    buffer_load_dwordx4 v14, s[60:63], s21 offen sc1 lds
    s_add_u32 m0, s82, 63488
    s_add_u32 s21, s21, 33792
    s_mov_b32 exec_hi, 0
    buffer_load_dwordx4 v14, s[60:63], s21 offen sc1 lds
    s_mov_b64 exec, -1
    s_waitcnt vmcnt(14)
    v_mfma_f32_16x16x32_bf16 v[236:239], v[28:31], v[172:175], v[236:239]
    v_mfma_f32_16x16x32_bf16 v[240:243], v[32:35], v[172:175], v[240:243]
    ds_write_b128 v6, v[212:215] offset:4096
    v_mfma_f32_16x16x32_bf16 v[244:247], v[36:39], v[172:175], v[244:247]
    v_mfma_f32_16x16x32_bf16 v[248:251], v[40:43], v[172:175], v[248:251]
    ds_write_b128 v6, v[216:219] offset:20480
    v_mfma_f32_16x16x32_bf16 v[252:255], v[44:47], v[172:175], v[252:255]
    s_waitcnt vmcnt(7)
    v_mfma_f32_16x16x32_bf16 v[236:239], v[88:91], v[140:143], v[236:239]
    ds_write_b128 v6, v[220:223] offset:21504
    v_mfma_f32_16x16x32_bf16 v[240:243], v[92:95], v[140:143], v[240:243]
    v_mfma_f32_16x16x32_bf16 v[244:247], v[96:99], v[140:143], v[244:247]
    ds_write_b128 v6, v[224:227] offset:22528
    v_mfma_f32_16x16x32_bf16 v[248:251], v[100:103], v[140:143], v[248:251]
    v_mfma_f32_16x16x32_bf16 v[252:255], v[104:107], v[140:143], v[252:255]
    ds_write_b128 v6, v[228:231] offset:23552
    s_waitcnt vmcnt(13)
    v_mfma_f32_16x16x32_bf16 v[176:179], v[28:31], v[160:163], v[176:179]
    v_mfma_f32_16x16x32_bf16 v[180:183], v[32:35], v[160:163], v[180:183]
    ds_write_b128 v6, v[232:235] offset:24576
    v_mfma_f32_16x16x32_bf16 v[184:187], v[36:39], v[160:163], v[184:187]
    v_mfma_f32_16x16x32_bf16 v[188:191], v[40:43], v[160:163], v[188:191]
    ds_write_b128 v6, v[236:239] offset:40960
    v_mfma_f32_16x16x32_bf16 v[192:195], v[44:47], v[160:163], v[192:195]
    s_waitcnt vmcnt(6)
    v_mfma_f32_16x16x32_bf16 v[176:179], v[88:91], v[128:131], v[176:179]
    ds_write_b128 v6, v[240:243] offset:41984
    v_mfma_f32_16x16x32_bf16 v[180:183], v[92:95], v[128:131], v[180:183]
    v_mfma_f32_16x16x32_bf16 v[184:187], v[96:99], v[128:131], v[184:187]
    ds_write_b128 v6, v[244:247] offset:43008
    v_mfma_f32_16x16x32_bf16 v[188:191], v[100:103], v[128:131], v[188:191]
    v_mfma_f32_16x16x32_bf16 v[192:195], v[104:107], v[128:131], v[192:195]
    ds_write_b128 v6, v[248:251] offset:44032
    s_waitcnt vmcnt(4)
    v_mfma_f32_16x16x32_bf16 v[176:179], v[68:71], v[144:147], v[176:179]
    v_mfma_f32_16x16x32_bf16 v[180:183], v[72:75], v[144:147], v[180:183]
    ds_write_b128 v6, v[252:255] offset:45056
    v_mfma_f32_16x16x32_bf16 v[184:187], v[76:79], v[144:147], v[184:187]
    v_mfma_f32_16x16x32_bf16 v[188:191], v[80:83], v[144:147], v[188:191]
    v_mfma_f32_16x16x32_bf16 v[192:195], v[84:87], v[144:147], v[192:195]
    s_waitcnt vmcnt(0) lgkmcnt(0)
    s_barrier
    ds_read_b64_tr_b16 v[100:101], v15 offset:0
    ds_read_b128 v[112:115], v25 offset:0
    ds_read_b128 v[116:119], v26 offset:0
    ds_read_b128 v[120:123], v27 offset:0
    ds_read_b64_tr_b16 v[102:103], v15 offset:512
    ds_read_b128 v[124:127], v25 offset:1024
    ds_read_b128 v[128:131], v26 offset:1024
    ds_read_b128 v[132:135], v27 offset:1024
    ds_read_b64_tr_b16 v[104:105], v15 offset:1024
    ds_read_b128 v[136:139], v25 offset:2048
    ds_read_b128 v[140:143], v26 offset:2048
    ds_read_b128 v[144:147], v27 offset:2048
    ds_read_b64_tr_b16 v[106:107], v15 offset:1536
    ds_read_b128 v[148:151], v25 offset:3072
    ds_read_b128 v[152:155], v26 offset:3072
    ds_read_b128 v[156:159], v27 offset:3072
    ds_read_b64_tr_b16 v[108:109], v15 offset:2048
    ds_read_b128 v[160:163], v25 offset:4096
    ds_read_b128 v[164:167], v26 offset:4096
    ds_read_b128 v[168:171], v27 offset:4096
    s_waitcnt lgkmcnt(15)
    v_lshlrev_b32 v40, 16, v100
    v_and_b32 v41, s22, v100
    v_lshlrev_b32 v42, 16, v101
    v_and_b32 v43, s22, v101
    v_pk_add_f32 v[112:113], v[112:113], v[116:117]
    v_pk_add_f32 v[114:115], v[114:115], v[118:119]
    v_pk_add_f32 v[176:177], v[176:177], v[120:121]
    v_pk_add_f32 v[178:179], v[178:179], v[122:123]
    v_pk_add_f32 v[112:113], v[112:113], v[40:41]
    v_pk_add_f32 v[114:115], v[114:115], v[42:43]
    v_pk_add_f32 v[176:177], v[176:177], v[112:113]
    v_pk_add_f32 v[178:179], v[178:179], v[114:115]
    v_cvt_pk_bf16_f32 v28, v176, v177
    v_cvt_pk_bf16_f32 v29, v178, v179
    ds_write_b64 v10, v[28:29] offset:0
    s_waitcnt lgkmcnt(13)
    v_lshlrev_b32 v40, 16, v102
    v_and_b32 v41, s22, v102
    v_lshlrev_b32 v42, 16, v103
    v_and_b32 v43, s22, v103
    v_pk_add_f32 v[124:125], v[124:125], v[128:129]
    v_pk_add_f32 v[126:127], v[126:127], v[130:131]
    v_pk_add_f32 v[180:181], v[180:181], v[132:133]
    v_pk_add_f32 v[182:183], v[182:183], v[134:135]
    v_pk_add_f32 v[124:125], v[124:125], v[40:41]
    v_pk_add_f32 v[126:127], v[126:127], v[42:43]
    v_pk_add_f32 v[180:181], v[180:181], v[124:125]
    v_pk_add_f32 v[182:183], v[182:183], v[126:127]
    v_cvt_pk_bf16_f32 v30, v180, v181
    v_cvt_pk_bf16_f32 v31, v182, v183
    ds_write_b64 v10, v[30:31] offset:8
    s_waitcnt lgkmcnt(10)
    v_lshlrev_b32 v40, 16, v104
    v_and_b32 v41, s22, v104
    v_lshlrev_b32 v42, 16, v105
    v_and_b32 v43, s22, v105
    v_pk_add_f32 v[136:137], v[136:137], v[140:141]
    v_pk_add_f32 v[138:139], v[138:139], v[142:143]
    v_pk_add_f32 v[184:185], v[184:185], v[144:145]
    v_pk_add_f32 v[186:187], v[186:187], v[146:147]
    v_pk_add_f32 v[136:137], v[136:137], v[40:41]
    v_pk_add_f32 v[138:139], v[138:139], v[42:43]
    v_pk_add_f32 v[184:185], v[184:185], v[136:137]
    v_pk_add_f32 v[186:187], v[186:187], v[138:139]
    v_cvt_pk_bf16_f32 v32, v184, v185
    v_cvt_pk_bf16_f32 v33, v186, v187
    ds_write_b64 v10, v[32:33] offset:16
    s_waitcnt lgkmcnt(7)
    v_lshlrev_b32 v40, 16, v106
    v_and_b32 v41, s22, v106
    v_lshlrev_b32 v42, 16, v107
    v_and_b32 v43, s22, v107
    v_pk_add_f32 v[148:149], v[148:149], v[152:153]
    v_pk_add_f32 v[150:151], v[150:151], v[154:155]
    v_pk_add_f32 v[188:189], v[188:189], v[156:157]
    v_pk_add_f32 v[190:191], v[190:191], v[158:159]
    v_pk_add_f32 v[148:149], v[148:149], v[40:41]
    v_pk_add_f32 v[150:151], v[150:151], v[42:43]
    v_pk_add_f32 v[188:189], v[188:189], v[148:149]
    v_pk_add_f32 v[190:191], v[190:191], v[150:151]
    v_cvt_pk_bf16_f32 v34, v188, v189
    v_cvt_pk_bf16_f32 v35, v190, v191
    ds_write_b64 v10, v[34:35] offset:24
    s_waitcnt lgkmcnt(4)
    v_lshlrev_b32 v40, 16, v108
    v_and_b32 v41, s22, v108
    v_lshlrev_b32 v42, 16, v109
    v_and_b32 v43, s22, v109
    v_pk_add_f32 v[160:161], v[160:161], v[164:165]
    v_pk_add_f32 v[162:163], v[162:163], v[166:167]
    v_pk_add_f32 v[192:193], v[192:193], v[168:169]
    v_pk_add_f32 v[194:195], v[194:195], v[170:171]
    v_pk_add_f32 v[160:161], v[160:161], v[40:41]
    v_pk_add_f32 v[162:163], v[162:163], v[42:43]
    v_pk_add_f32 v[192:193], v[192:193], v[160:161]
    v_pk_add_f32 v[194:195], v[194:195], v[162:163]
    v_cvt_pk_bf16_f32 v36, v192, v193
    v_cvt_pk_bf16_f32 v37, v194, v195
    ds_write_b64 v10, v[36:37] offset:32
    ds_read_b128 v[48:51], v7 offset:20480
    ds_read_b128 v[52:55], v7 offset:21440
    ds_read_b128 v[56:59], v7 offset:22400
    s_mov_b32 exec_hi, 0x0fffffff
    s_waitcnt lgkmcnt(2)
    buffer_store_dwordx4 v[48:51], v11, s[56:59], s20 offen
    s_add_u32 s20, s20, 7680
    s_waitcnt lgkmcnt(1)
    buffer_store_dwordx4 v[52:55], v11, s[56:59], s20 offen
    s_add_u32 s20, s20, 7680
    s_waitcnt lgkmcnt(0)
    s_mov_b32 exec_hi, 0xff
    buffer_store_dwordx4 v[56:59], v11, s[56:59], s20 offen
    s_add_u32 s20, s20, 7680
    s_mov_b64 exec, -1
    s_branch L_done
L_aux:
    s_mov_b32 s83, 1
    s_mov_b32 s57, 0
    s_mov_b32 s56, 0
    s_max_u32 s8, s2, 32
    s_mul_i32 s58, s2, 5
    s_add_u32 s58, s58, s8
    s_add_u32 s58, s58, 400
    v_mov_b32 v252, 0
    v_mov_b32 v253, 0
    s_cmp_ge_u32 s2, 32
    s_cselect_b32 s8, 6, 5
    s_cmp_ge_u32 s3, s8
    s_cbranch_scc1 L_aux_nok
    s_mul_i32 s73, s3, 15104
    s_add_u32 s8, s73, 43008
    s_sub_u32 s73, s73, 60416
    s_cmp_lt_u32 s3, 4
    s_cmov_b32 s73, s8
    s_mov_b32 s74, s73
    s_add_u32 s75, s73, 4608
    s_add_u32 s72, s58, s3
    s_lshl_b32 s9, s72, 1
    v_mov_b32 v1, s9
    s_lshl_b32 s9, s72, 8
    v_lshl_add_u32 v2, v0, 1, s9
    v_mov_b32 v9, 0
    v_mov_b32 v10, 0
    v_mov_b32 v11, 0
    v_mov_b32 v12, 0
    v_mov_b32 v13, 0
    v_mov_b32 v14, 0
    v_mov_b32 v18, 0
    v_mov_b32 v248, 0
    v_mov_b32 v249, 0
    v_mov_b32 v250, 0
    v_mov_b32 v251, 0
    s_and_b32 s8, s3, 1
    s_add_u32 s8, s8, s58
    s_lshl1_add_u32 s8, s8, 8
    v_mov_b32 v20, s8
    s_waitcnt lgkmcnt(0)
    global_load_short_d16_hi v14, v1, s[26:27]
    global_load_short_d16_hi v10, v2, s[18:19]
    global_load_short_d16_hi v248, v2, s[18:19] offset:128
    global_load_short_d16_hi v11, v2, s[20:21]
    global_load_short_d16_hi v249, v2, s[20:21] offset:128
    global_load_short_d16_hi v12, v2, s[22:23]
    global_load_short_d16_hi v250, v2, s[22:23] offset:128
    global_load_short_d16_hi v13, v2, s[24:25]
    global_load_short_d16_hi v251, v2, s[24:25] offset:128
    global_load_short_d16_hi v18, v1, s[28:29]
    global_load_short_d16_hi v9, v20, s[28:29]
    s_add_u32 s48, s42, 65536
    s_addc_u32 s49, s43, 0
    s_mov_b32 s50, 2654208
    s_mov_b32 s51, 0x20000
    s_add_u32 s84, s42, 15667200
    s_addc_u32 s85, s43, 0
    s_mov_b32 s86, 609280
    s_mov_b32 s87, 0x20000
    s_add_u32 s52, s42, 12963840
    s_addc_u32 s53, s43, 0
    s_mov_b32 s54, 2703360
    s_mov_b32 s55, 0x20000
    s_cmp_lt_u32 s3, 4
    s_cbranch_scc1 L_aux_rows
    s_barrier
    s_waitcnt vmcnt(0)
    s_branch L_kgen
L_aux_rows:
    v_lshrrev_b32 v220, 5, v0
    v_and_b32 v221, 31, v0
    v_mul_u32_u24 v222, 1280, v220
    v_lshl_add_u32 v222, v221, 3, v222
    s_lshl2_add_u32 s9, s88, s3
    s_mul_i32 s9, s9, 2560
    v_add_u32 v222, s9, v222
    global_load_dwordx2 v[208:209], v222, s[16:17] offset:0
    global_load_dwordx2 v[210:211], v222, s[16:17] offset:256
    global_load_dwordx2 v[212:213], v222, s[16:17] offset:512
    global_load_dwordx2 v[214:215], v222, s[16:17] offset:768
    global_load_dwordx2 v[216:217], v222, s[16:17] offset:1024
    s_waitcnt vmcnt(5)
    s_branch L_kgen
L_aux_kpass:
    s_cmp_eq_u32 s56, 1
    s_cbranch_scc1 L_aux_kdone
    s_cmp_lt_u32 s3, 4
    s_cbranch_scc1 L_ln2
    s_branch L_aux_k2
L_aux_rowsdone:
    s_barrier
L_aux_k2:
    global_load_dword v252, v253, s[40:41] sc1
    s_mov_b32 s56, 1
    v_mov_b32 v10, v248
    v_mov_b32 v11, v249
    v_mov_b32 v12, v250
    v_mov_b32 v13, v251
    s_branch L_kgpass
L_aux_kdone:
    s_nop 4
    v_cvt_pk_bf16_f32 v20, v192, v193
    v_cvt_pk_bf16_f32 v21, v194, v195
    v_cvt_pk_bf16_f32 v22, v196, v197
    v_cvt_pk_bf16_f32 v23, v198, v199
    ds_write_b32 v5, v20
    ds_write_b32 v6, v21
    s_mov_b32 exec_lo, 0x001f001f
    s_mov_b32 exec_hi, 0x001f001f
    ds_write_b64 v8, v[22:23] offset:1024
    s_mov_b64 exec, -1
    v_add_u32 v5, v5, v7
    v_add_u32 v6, v6, v7
    v_add_u32 v8, 32, v8
    v_cvt_pk_bf16_f32 v20, v200, v201
    v_cvt_pk_bf16_f32 v21, v202, v203
    v_cvt_pk_bf16_f32 v22, v204, v205
    v_cvt_pk_bf16_f32 v23, v206, v207
    ds_write_b32 v5, v20
    ds_write_b32 v6, v21
    s_mov_b32 exec_lo, 0x001f001f
    s_mov_b32 exec_hi, 0x001f001f
    ds_write_b64 v8, v[22:23] offset:1024
    s_mov_b64 exec, -1
    s_mov_b32 s8, 0x01000100
    s_mov_b32 s9, 0x03020302
    v_lshlrev_b32 v74, 3, v0
    v_add_u32 v78, s75, v74
    v_lshlrev_b32 v79, 2, v0
    v_add_u32 v79, s75, v79
    ds_read_b64 v[64:65], v78
    ds_read_b64 v[66:67], v78 offset:8
    ds_read2_b32 v[68:69], v79 offset0:128 offset1:129
    v_mov_b32 v72, 0
    v_mov_b32 v73, 0
    v_add_u32 v74, s74, v74
    v_and_b32 v78, 3, v0
    v_bfe_u32 v79, v0, 2, 2
    v_mul_u32_u24 v79, 2624, v79
    v_lshl_add_u32 v79, v78, 3, v79
    v_add_u32 v79, s74, v79
    v_cmp_eq_u32 vcc, 63, v0
    v_mov_b32 v76, 0x03020100
    v_mov_b32 v78, 0x01000100
    v_cndmask_b32 v76, v76, v78, vcc
    v_mov_b32 v77, 0x07060504
    v_mov_b32 v78, 0x03020302
    v_cndmask_b32 v77, v77, v78, vcc
    s_waitcnt lgkmcnt(0)
    v_perm_b32 v67, v67, v66, v77
    v_perm_b32 v66, v66, v66, v76
    v_alignbit_b32 v80, v65, v64, 16
    v_alignbit_b32 v81, v66, v65, 16
    v_mov_b32 v82, v65
    v_mov_b32 v83, v66
    v_alignbit_b32 v84, v66, v65, 16
    v_alignbit_b32 v85, v67, v66, 16
    v_lshlrev_b32 v86, 16, v64
    v_alignbit_b32 v87, v65, v64, 16
    v_perm_b32 v69, v69, v69, v76
    v_perm_b32 v88, v68, v68, s8
    v_alignbit_b32 v89, v69, v68, 16
    v_mov_b32 v90, v68
    v_perm_b32 v91, v69, v69, s8
    v_alignbit_b32 v92, v69, v68, 16
    v_perm_b32 v93, v69, v69, s8
    v_perm_b32 v94, v69, v69, s8
    v_mov_b32 v95, v69
    s_mov_b32 s8, 0x01000100
    s_mov_b32 s9, 0x03020302
    v_lshl_add_u32 v132, v0, 2, s75
    v_add_u32 v133, 1024, v132
    ds_read2_b32 v[128:129], v132 offset0:192 offset1:193
    ds_read2_b32 v[130:131], v133 offset0:0 offset1:1
    v_lshl_add_u32 v132, v0, 4, s74
    v_lshl_add_u32 v133, v0, 1, s74
    v_mov_b32 v135, s74
    v_mov_b32 v136, 0
    v_mov_b32 v137, 0
    v_mov_b32 v138, 0
    v_mov_b32 v139, 0
    v_lshrrev_b32 v134, 5, v0
    v_mul_u32_u24 v134, 2112, v134
    v_add_u32 v134, v134, v132
    s_waitcnt lgkmcnt(0)
    v_perm_b32 v140, v128, v128, s8
    v_mov_b32 v141, v128
    v_perm_b32 v142, v128, v128, s9
    v_perm_b32 v143, v129, v129, s8
    v_perm_b32 v144, v128, v128, s8
    v_perm_b32 v145, v128, v128, s9
    v_alignbit_b32 v146, v129, v128, 16
    v_perm_b32 v147, v129, v129, s8
    v_mov_b32 v148, v128
    v_perm_b32 v149, v128, v128, s9
    v_perm_b32 v150, v129, v129, s8
    v_perm_b32 v151, v129, v129, s8
    v_perm_b32 v152, v128, v128, s9
    v_alignbit_b32 v153, v129, v128, 16
    v_perm_b32 v154, v129, v129, s8
    v_perm_b32 v155, v129, v129, s8
    v_perm_b32 v156, v130, v130, s8
    v_perm_b32 v157, v130, v130, s8
    v_and_b32 v158, 0xffff, v130
    ds_write_b64 v74, v[72:73] offset:10496
    ds_write_b64 v79, v[72:73]
    ds_write_b64 v74, v[64:65] offset:32
    ds_write_b64 v74, v[80:81] offset:2656
    ds_write_b64 v74, v[82:83] offset:5280
    ds_write_b64 v74, v[84:85] offset:7904
    s_mov_b64 exec, 1
    ds_write_b32 v74, v86 offset:2652
    ds_write_b32 v74, v64 offset:5276
    ds_write_b64 v74, v[86:87] offset:7896
    s_mov_b64 exec, -1
    ds_write_b64 v74, v[88:89] offset:544
    ds_write_b64 v74, v[90:91] offset:3168
    ds_write_b64 v74, v[92:93] offset:5792
    ds_write_b64 v74, v[94:95] offset:8416
    ds_write_b128 v134, v[136:139] offset:2080
    ds_write_b128 v134, v[136:139] offset:7328
    ds_write_b128 v132, v[140:143] offset:1056
    ds_write_b128 v132, v[144:147] offset:3680
    ds_write_b128 v132, v[148:151] offset:6304
    ds_write_b128 v132, v[152:155] offset:8928
    ds_write_b16_d16_hi v133, v130 offset:2272
    ds_write_b16 v133, v131 offset:2432
    ds_write_b16_d16_hi v133, v130 offset:4894
    ds_write_b16 v133, v131 offset:5054
    ds_write_b16_d16_hi v133, v130 offset:7516
    ds_write_b16 v133, v131 offset:7676
    ds_write_b16_d16_hi v133, v130 offset:10138
    ds_write_b16 v133, v131 offset:10298
    s_mov_b64 exec, 1
    ds_write_b64 v135, v[156:157] offset:2080
    ds_write_b32 v135, v158 offset:2088
    ds_write_b64 v135, v[156:157] offset:4704
    ds_write_b32 v135, v156 offset:7328
    ds_write_b32 v135, v158 offset:7332
    ds_write_b32 v135, v156 offset:9952
    s_mov_b64 exec, -1
L_aux_kall:
    v_mov_b32 v8, v9
    v_lshlrev_b32 v4, 4, v0
    v_and_b32 v6, 15, v0
    v_lshrrev_b32 v7, 4, v0
    s_waitcnt vmcnt(0)
L_nc_31:
    v_readfirstlane_b32 s95, v252
    s_cmp_lg_u32 s95, 0
    s_cbranch_scc1 L_nc_32
    s_add_u32 s89, s89, 1
    s_cmp_ge_u32 s89, 400000
    s_cbranch_scc1 L_nc_32
    s_sleep 4
    global_load_dword v252, v253, s[40:41] sc1
    s_waitcnt vmcnt(0)
    s_branch L_nc_31
L_nc_32:
    s_mov_b32 s15, 1
    s_waitcnt lgkmcnt(0)
    s_cmp_ge_u32 s3, 4
    s_cbranch_scc1 L_aux_g
    s_add_u32 s68, s42, 3674112
    s_addc_u32 s69, s43, 0
    s_mov_b32 s70, 2211840
    s_mov_b32 s71, 0x20000
    s_mul_i32 s60, s91, 54
    s_add_u32 s60, s60, s3
    s_add_u32 s60, s60, 40
    s_mul_i32 s60, s60, 5120
    v_add_u32 v9, 4096, v4
    v_min_u32 v20, 2, v0
    v_lshlrev_b32 v20, 9, v20
    s_lshr_b32 s8, s91, 1
    s_mul_i32 s8, s8, 54
    s_add_u32 s8, s8, s3
    s_lshl_b32 s8, s8, 7
    s_add_u32 s8, s8, 25600
    s_mov_b32 s62, s8
    v_mov_b32 v26, v20
    s_cmp_ge_u32 s3, 2
    s_cbranch_scc1 L_aux_gat
    buffer_load_dword v27, v26, s[84:87], s62 offen sc1
    s_waitcnt vmcnt(0)
L_cw_33:
    v_cmp_ne_u32 vcc, s95, v27
    s_cmp_eq_u64 vcc, 0
    s_cbranch_scc1 L_cw_34
    s_add_u32 s89, s89, 1
    s_cmp_ge_u32 s89, 400000
    s_cbranch_scc1 L_cw_34
    s_sleep 12
    buffer_load_dword v27, v26, s[84:87], s62 offen sc1
    s_waitcnt vmcnt(0)
    s_branch L_cw_33
L_cw_34:
    buffer_load_dwordx4 v[192:195], v4, s[68:71], s60 offen offset:0 sc1
    buffer_load_dwordx4 v[196:199], v4, s[68:71], s60 offen offset:1024 sc1
    buffer_load_dwordx4 v[200:203], v4, s[68:71], s60 offen offset:2048 sc1
    buffer_load_dwordx4 v[204:207], v4, s[68:71], s60 offen offset:3072 sc1
    buffer_load_dwordx4 v[208:211], v9, s[68:71], s60 offen offset:0 sc1
    s_add_u32 s60, s60, 20480
    buffer_load_dwordx4 v[212:215], v4, s[68:71], s60 offen offset:0 sc1
    buffer_load_dwordx4 v[216:219], v4, s[68:71], s60 offen offset:1024 sc1
    buffer_load_dwordx4 v[220:223], v4, s[68:71], s60 offen offset:2048 sc1
    buffer_load_dwordx4 v[224:227], v4, s[68:71], s60 offen offset:3072 sc1
    buffer_load_dwordx4 v[228:231], v9, s[68:71], s60 offen offset:0 sc1
    s_add_u32 s60, s60, 20480
    buffer_load_dwordx4 v[232:235], v4, s[68:71], s60 offen offset:0 sc1
    buffer_load_dwordx4 v[236:239], v4, s[68:71], s60 offen offset:1024 sc1
    buffer_load_dwordx4 v[240:243], v4, s[68:71], s60 offen offset:2048 sc1
    buffer_load_dwordx4 v[244:247], v4, s[68:71], s60 offen offset:3072 sc1
    buffer_load_dwordx4 v[248:251], v9, s[68:71], s60 offen offset:0 sc1
    s_add_u32 s60, s60, 20480
    s_branch L_aux_nog
L_aux_gat:
    v_mul_u32_u24 v20, 10923, v0
    v_lshrrev_b32 v20, 16, v20
    v_mul_u32_u24 v21, 6, v20
    v_sub_u32 v21, v0, v21
    v_mul_u32_u24 v22, 10368, v20
    v_lshl_add_u32 v22, v21, 4, v22
    v_cmp_gt_u32 vcc, 4, v21
    v_mul_u32_u24 v23, 15104, v21
    v_add_u32 v24, 43008, v23
    v_subrev_u32 v23, 60416, v23
    v_cndmask_b32 v23, v23, v24, vcc
    v_lshl_add_u32 v23, v20, 4, v23
    s_and_b32 s9, s3, 1
    s_mul_i32 s10, s9, 2080
    v_add_u32 v23, s10, v23
    s_lshl_b32 s8, s2, 9
    v_and_b32 v24, 3, v0
    v_lshlrev_b32 v24, 7, v24
    buffer_load_dword v25, v24, s[84:87], s8 offen offset:0 sc1
    buffer_load_dword v27, v26, s[84:87], s62 offen sc1
    s_waitcnt vmcnt(0)
L_lnf2_35:
    v_cmp_ne_u32 vcc, s95, v25
    v_cmp_ne_u32 s[80:81], s95, v27
    s_or_b64 vcc, vcc, s[80:81]
    s_cmp_eq_u64 vcc, 0
    s_cbranch_scc1 L_lnf2_36
    s_add_u32 s89, s89, 1
    s_cmp_ge_u32 s89, 400000
    s_cbranch_scc1 L_lnf2_36
    s_sleep 4
    buffer_load_dword v25, v24, s[84:87], s8 offen offset:0 sc1
    buffer_load_dword v27, v26, s[84:87], s62 offen sc1
    s_waitcnt vmcnt(0)
    s_branch L_lnf2_35
L_lnf2_36:
    s_mul_i32 s8, s9, 1347840
    s_lshl4_add_u32 s8, s58, s8
    s_mov_b32 exec_hi, 0x0fffffff
    buffer_load_dwordx4 v[64:67], v22, s[48:51], s8 offen sc1
    s_add_u32 s8, s8, 103680
    buffer_load_dwordx4 v[68:71], v22, s[48:51], s8 offen sc1
    s_add_u32 s8, s8, 103680
    buffer_load_dwordx4 v[72:75], v22, s[48:51], s8 offen sc1
    s_add_u32 s8, s8, 103680
    buffer_load_dwordx4 v[76:79], v22, s[48:51], s8 offen sc1
    s_add_u32 s8, s8, 103680
    buffer_load_dwordx4 v[80:83], v22, s[48:51], s8 offen sc1
    s_add_u32 s8, s8, 103680
    buffer_load_dwordx4 v[84:87], v22, s[48:51], s8 offen sc1
    s_add_u32 s8, s8, 103680
    buffer_load_dwordx4 v[88:91], v22, s[48:51], s8 offen sc1
    s_add_u32 s8, s8, 103680
    buffer_load_dwordx4 v[92:95], v22, s[48:51], s8 offen sc1
    s_add_u32 s8, s8, 103680
    buffer_load_dwordx4 v[96:99], v22, s[48:51], s8 offen sc1
    s_add_u32 s8, s8, 103680
    buffer_load_dwordx4 v[100:103], v22, s[48:51], s8 offen sc1
    s_add_u32 s8, s8, 103680
    buffer_load_dwordx4 v[104:107], v22, s[48:51], s8 offen sc1
    s_add_u32 s8, s8, 103680
    buffer_load_dwordx4 v[108:111], v22, s[48:51], s8 offen sc1
    s_add_u32 s8, s8, 103680
    buffer_load_dwordx4 v[112:115], v22, s[48:51], s8 offen sc1
    s_add_u32 s8, s8, 103680
    s_cmp_eq_u32 s9, 1
    s_cselect_b32 s10, 15, exec_hi
    s_mov_b32 exec_hi, -1
    buffer_load_dwordx4 v[192:195], v4, s[68:71], s60 offen offset:0 sc1
    buffer_load_dwordx4 v[196:199], v4, s[68:71], s60 offen offset:1024 sc1
    buffer_load_dwordx4 v[200:203], v4, s[68:71], s60 offen offset:2048 sc1
    buffer_load_dwordx4 v[204:207], v4, s[68:71], s60 offen offset:3072 sc1
    buffer_load_dwordx4 v[208:211], v9, s[68:71], s60 offen offset:0 sc1
    s_add_u32 s60, s60, 20480
    buffer_load_dwordx4 v[212:215], v4, s[68:71], s60 offen offset:0 sc1
    s_mov_b32 exec_hi, 0x0fffffff
    s_waitcnt vmcnt(18)
    ds_write_b128 v23, v[64:67] offset:11008
    s_waitcnt vmcnt(17)
    ds_write_b128 v23, v[68:71] offset:11168
    s_waitcnt vmcnt(16)
    ds_write_b128 v23, v[72:75] offset:11328
    s_waitcnt vmcnt(15)
    ds_write_b128 v23, v[76:79] offset:11488
    s_waitcnt vmcnt(14)
    ds_write_b128 v23, v[80:83] offset:11648
    s_waitcnt vmcnt(13)
    ds_write_b128 v23, v[84:87] offset:11808
    s_waitcnt vmcnt(12)
    ds_write_b128 v23, v[88:91] offset:11968
    s_waitcnt vmcnt(11)
    ds_write_b128 v23, v[92:95] offset:12128
    s_waitcnt vmcnt(10)
    ds_write_b128 v23, v[96:99] offset:12288
    s_waitcnt vmcnt(9)
    ds_write_b128 v23, v[100:103] offset:12448
    s_waitcnt vmcnt(8)
    ds_write_b128 v23, v[104:107] offset:12608
    s_waitcnt vmcnt(7)
    ds_write_b128 v23, v[108:111] offset:12768
    s_waitcnt vmcnt(6)
    s_mov_b32 exec_hi, s10
    ds_write_b128 v23, v[112:115] offset:12928
    s_mov_b64 exec, -1
    s_lshl2_add_u32 s8, s9, 42560
    v_mov_b32 v24, s8
    ds_write_b32 v24, v252
    buffer_load_dwordx4 v[216:219], v4, s[68:71], s60 offen offset:1024 sc1
    buffer_load_dwordx4 v[220:223], v4, s[68:71], s60 offen offset:2048 sc1
    buffer_load_dwordx4 v[224:227], v4, s[68:71], s60 offen offset:3072 sc1
    buffer_load_dwordx4 v[228:231], v9, s[68:71], s60 offen offset:0 sc1
    s_add_u32 s60, s60, 20480
    buffer_load_dwordx4 v[232:235], v4, s[68:71], s60 offen offset:0 sc1
    buffer_load_dwordx4 v[236:239], v4, s[68:71], s60 offen offset:1024 sc1
    buffer_load_dwordx4 v[240:243], v4, s[68:71], s60 offen offset:2048 sc1
    buffer_load_dwordx4 v[244:247], v4, s[68:71], s60 offen offset:3072 sc1
    buffer_load_dwordx4 v[248:251], v9, s[68:71], s60 offen offset:0 sc1
    s_add_u32 s60, s60, 20480
L_aux_nog:
    v_and_b32 v20, 1, v0
    v_lshlrev_b32 v20, 2, v20
    v_add_u32 v20, 42560, v20
    ds_read_b32 v21, v20
    s_waitcnt lgkmcnt(0)
L_lnw_37:
    v_cmp_ne_u32 vcc, s95, v21
    s_cmp_eq_u64 vcc, 0
    s_cbranch_scc1 L_lnw_38
    s_add_u32 s89, s89, 1
    s_cmp_ge_u32 s89, 400000
    s_cbranch_scc1 L_lnw_38
    s_sleep 2
    ds_read_b32 v21, v20
    s_waitcnt lgkmcnt(0)
    s_branch L_lnw_37
L_lnw_38:
    s_mov_b32 s78, 0
    s_branch L_conv
L_aux_cdone:
    s_and_b32 s8, s3, 1
    s_cmp_ge_u32 s2, 32
    s_cselect_b32 s9, 2, 1
    s_cmp_lt_u32 s8, s9
    s_cselect_b32 s12, 1, 0
    v_mov_b32 v18, v8
    s_mov_b32 s63, s61
    s_cmp_eq_u32 s12, 1
    s_cbranch_scc1 L_aux_2nd
    s_waitcnt vmcnt(0)
    s_add_u32 s13, s63, 4096
    s_mov_b64 exec, 1
    buffer_store_dword v17, off, s[84:87], s63 sc1
    buffer_store_dword v17, off, s[84:87], s13 sc1
    s_mov_b64 exec, -1
    s_branch L_carry
L_aux_2nd:
    s_mov_b32 s83, 2
    s_mul_i32 s73, s8, 15104
    s_add_u32 s72, s58, s8
    s_add_u32 s72, s72, 4
    s_lshr_b32 s78, s3, 1
    s_branch L_conv
L_aux_nok:
    s_mov_b32 s15, 0
    v_lshlrev_b32 v30, 4, v0
    v_and_b32 v25, 3, v0
    v_lshlrev_b32 v29, 2, v0
    s_waitcnt lgkmcnt(0)
    s_lshl3_add_u32 s8, s2, s3
    s_cmp_lg_u32 s8, 7
    s_cbranch_scc1 L_nonp
    s_memrealtime s[8:9]
    s_waitcnt lgkmcnt(0)
    s_or_b32 s8, s8, 1
    v_mov_b32 v28, s8
    s_mov_b64 exec, 1
    global_store_dword v253, v28, s[40:41] sc1
    s_mov_b64 exec, -1
L_nonp:
    s_add_u32 s48, s42, 65536
    s_addc_u32 s49, s43, 0
    s_mov_b32 s50, 2654208
    s_mov_b32 s51, 0x20000
    s_add_u32 s84, s42, 15667200
    s_addc_u32 s85, s43, 0
    s_mov_b32 s86, 609280
    s_mov_b32 s87, 0x20000
    s_add_u32 s76, s42, 0
    s_addc_u32 s77, s43, 0
    s_mov_b32 s78, 32768
    s_mov_b32 s79, 0x20000
    v_bfe_u32 v9, v0, 2, 2
    v_mul_u32_u24 v9, 1312, v9
    v_lshl_add_u32 v9, v25, 3, v9
    v_lshrrev_b32 v10, 4, v0
    v_lshl_add_u32 v9, v10, 5, v9
    v_add_u32 v9, 147456, v9
    v_and_b32 v12, 7, v0
    v_lshlrev_b32 v12, 4, v12
    v_add_u32 v10, 157952, v12
    v_lshlrev_b32 v2, 5, v0
    v_lshlrev_b32 v36, 9, v0
    s_add_u32 s14, s2, 40
    s_cmp_eq_u32 s3, 6
    s_cmov_b32 s14, s2
    s_sub_u32 s8, 111, s2
    s_cmp_eq_u32 s3, 7
    s_cmov_b32 s14, s8
    v_lshrrev_b32 v24, 2, v0
    v_mul_u32_u24 v31, 1280, v24
    v_lshl_add_u32 v31, v25, 4, v31
    s_lshr_b32 s60, s14, 1
    s_and_b32 s61, s14, 1
    s_mul_i32 s10, s60, 40960
    s_mul_i32 s63, s61, 640
    s_add_u32 s10, s10, s63
    s_mul_i32 s8, s3, 5376
    s_add_u32 s8, s8, 76544
    v_mul_u32_u24 v27, 336, v24
    v_add_u32 v27, s8, v27
    v_lshl_add_u32 v26, v25, 4, v27
    v_mul_u32_u24 v28, 40, v25
    v_add_u32 v27, v27, v28
    s_mul_i32 s62, s61, 1105920
    s_mul_i32 s63, s60, 5120
    s_add_u32 s62, s62, s63
    s_mov_b32 s64, s36
    s_mov_b32 s65, s37
    s_mov_b32 s66, 2211840
    s_mov_b32 s67, 0x20000
    s_add_u32 s68, s42, 3674112
    s_addc_u32 s69, s43, 0
    s_mov_b32 s70, 2211840
    s_mov_b32 s71, 0x20000
    s_sleep 4
    buffer_load_dwordx4 v[128:131], v31, s[64:67], s10 offen offset:0
    buffer_load_dwordx4 v[132:135], v31, s[64:67], s10 offen offset:64
    buffer_load_dwordx4 v[136:139], v31, s[64:67], s10 offen offset:128
    buffer_load_dwordx4 v[140:143], v31, s[64:67], s10 offen offset:192
    buffer_load_dwordx4 v[144:147], v31, s[64:67], s10 offen offset:256
    buffer_load_dwordx4 v[168:171], v31, s[64:67], s10 offen offset:320
    buffer_load_dwordx4 v[172:175], v31, s[64:67], s10 offen offset:384
    buffer_load_dwordx4 v[176:179], v31, s[64:67], s10 offen offset:448
    buffer_load_dwordx4 v[180:183], v31, s[64:67], s10 offen offset:512
    buffer_load_dwordx4 v[184:187], v31, s[64:67], s10 offen offset:576
    s_add_u32 s10, s10, 20480
    buffer_load_dwordx4 v[148:151], v31, s[64:67], s10 offen offset:0
    buffer_load_dwordx4 v[152:155], v31, s[64:67], s10 offen offset:64
    buffer_load_dwordx4 v[156:159], v31, s[64:67], s10 offen offset:128
    buffer_load_dwordx4 v[160:163], v31, s[64:67], s10 offen offset:192
    buffer_load_dwordx4 v[164:167], v31, s[64:67], s10 offen offset:256
    buffer_load_dwordx4 v[188:191], v31, s[64:67], s10 offen offset:320
    buffer_load_dwordx4 v[192:195], v31, s[64:67], s10 offen offset:384
    buffer_load_dwordx4 v[196:199], v31, s[64:67], s10 offen offset:448
    buffer_load_dwordx4 v[200:203], v31, s[64:67], s10 offen offset:512
    buffer_load_dwordx4 v[204:207], v31, s[64:67], s10 offen offset:576
    s_waitcnt vmcnt(15)
    ds_write_b128 v26, v[128:131] offset:0
    ds_write_b128 v26, v[132:135] offset:64
    ds_write_b128 v26, v[136:139] offset:128
    ds_write_b128 v26, v[140:143] offset:192
    ds_write_b128 v26, v[144:147] offset:256
    ds_read_b64_tr_b16 v[48:49], v27 offset:0
    ds_read_b64_tr_b16 v[52:53], v27 offset:8
    ds_read_b64_tr_b16 v[56:57], v27 offset:16
    ds_read_b64_tr_b16 v[60:61], v27 offset:24
    ds_read_b64_tr_b16 v[64:65], v27 offset:32
    ds_read_b64_tr_b16 v[68:69], v27 offset:160
    ds_read_b64_tr_b16 v[72:73], v27 offset:168
    ds_read_b64_tr_b16 v[76:77], v27 offset:176
    ds_read_b64_tr_b16 v[80:81], v27 offset:184
    ds_read_b64_tr_b16 v[84:85], v27 offset:192
    s_waitcnt vmcnt(10)
    ds_write_b128 v26, v[168:171] offset:0
    ds_write_b128 v26, v[172:175] offset:64
    ds_write_b128 v26, v[176:179] offset:128
    ds_write_b128 v26, v[180:183] offset:192
    ds_write_b128 v26, v[184:187] offset:256
    ds_read_b64_tr_b16 v[88:89], v27 offset:0
    ds_read_b64_tr_b16 v[92:93], v27 offset:8
    ds_read_b64_tr_b16 v[96:97], v27 offset:16
    ds_read_b64_tr_b16 v[100:101], v27 offset:24
    ds_read_b64_tr_b16 v[104:105], v27 offset:32
    ds_read_b64_tr_b16 v[108:109], v27 offset:160
    ds_read_b64_tr_b16 v[112:113], v27 offset:168
    ds_read_b64_tr_b16 v[116:117], v27 offset:176
    ds_read_b64_tr_b16 v[120:121], v27 offset:184
    ds_read_b64_tr_b16 v[124:125], v27 offset:192
    s_waitcnt vmcnt(5)
    ds_write_b128 v26, v[148:151] offset:0
    ds_write_b128 v26, v[152:155] offset:64
    ds_write_b128 v26, v[156:159] offset:128
    ds_write_b128 v26, v[160:163] offset:192
    ds_write_b128 v26, v[164:167] offset:256
    ds_read_b64_tr_b16 v[50:51], v27 offset:0
    ds_read_b64_tr_b16 v[54:55], v27 offset:8
    ds_read_b64_tr_b16 v[58:59], v27 offset:16
    ds_read_b64_tr_b16 v[62:63], v27 offset:24
    ds_read_b64_tr_b16 v[66:67], v27 offset:32
    ds_read_b64_tr_b16 v[70:71], v27 offset:160
    ds_read_b64_tr_b16 v[74:75], v27 offset:168
    ds_read_b64_tr_b16 v[78:79], v27 offset:176
    ds_read_b64_tr_b16 v[82:83], v27 offset:184
    ds_read_b64_tr_b16 v[86:87], v27 offset:192
    s_waitcnt vmcnt(0)
    ds_write_b128 v26, v[188:191] offset:0
    ds_write_b128 v26, v[192:195] offset:64
    ds_write_b128 v26, v[196:199] offset:128
    ds_write_b128 v26, v[200:203] offset:192
    ds_write_b128 v26, v[204:207] offset:256
    ds_read_b64_tr_b16 v[90:91], v27 offset:0
    ds_read_b64_tr_b16 v[94:95], v27 offset:8
    ds_read_b64_tr_b16 v[98:99], v27 offset:16
    ds_read_b64_tr_b16 v[102:103], v27 offset:24
    ds_read_b64_tr_b16 v[106:107], v27 offset:32
    ds_read_b64_tr_b16 v[110:111], v27 offset:160
    ds_read_b64_tr_b16 v[114:115], v27 offset:168
    ds_read_b64_tr_b16 v[118:119], v27 offset:176
    ds_read_b64_tr_b16 v[122:123], v27 offset:184
    ds_read_b64_tr_b16 v[126:127], v27 offset:192
    s_barrier
    global_load_dword v252, v253, s[40:41] sc1
    s_cmp_lg_u32 s3, 7
    s_cbranch_scc1 L_aux_norows
    ds_read_b64_tr_b16 v[208:209], v9 offset:0
    ds_read_b64_tr_b16 v[210:211], v9 offset:5248
    ds_read_b64_tr_b16 v[212:213], v9 offset:128
    ds_read_b64_tr_b16 v[214:215], v9 offset:5376
    ds_read_b64_tr_b16 v[216:217], v9 offset:256
    ds_read_b64_tr_b16 v[218:219], v9 offset:5504
    ds_read_b64_tr_b16 v[220:221], v9 offset:384
    ds_read_b64_tr_b16 v[222:223], v9 offset:5632
    ds_read_b64_tr_b16 v[224:225], v9 offset:512
    ds_read_b64_tr_b16 v[226:227], v9 offset:5760
    ds_read_b64_tr_b16 v[228:229], v9 offset:640
    ds_read_b64_tr_b16 v[230:231], v9 offset:5888
    ds_read_b64_tr_b16 v[232:233], v9 offset:768
    ds_read_b64_tr_b16 v[234:235], v9 offset:6016
    ds_read_b64_tr_b16 v[236:237], v9 offset:896
    ds_read_b64_tr_b16 v[238:239], v9 offset:6144
    ds_read_b64_tr_b16 v[240:241], v9 offset:1024
    ds_read_b64_tr_b16 v[242:243], v9 offset:6272
    ds_read_b64_tr_b16 v[244:245], v9 offset:1152
    ds_read_b64_tr_b16 v[246:247], v9 offset:6400
    ds_read_b128 v[32:35], v10
    s_mul_i32 s8, s88, 10368
    s_waitcnt lgkmcnt(15)
    buffer_store_dwordx4 v[208:211], v30, s[48:51], s8 offen sc1
    s_add_u32 s8, s8, 1024
    s_waitcnt lgkmcnt(15)
    buffer_store_dwordx4 v[212:215], v30, s[48:51], s8 offen sc1
    s_add_u32 s8, s8, 1024
    s_waitcnt lgkmcnt(15)
    buffer_store_dwordx4 v[216:219], v30, s[48:51], s8 offen sc1
    s_add_u32 s8, s8, 1024
    s_waitcnt lgkmcnt(13)
    buffer_store_dwordx4 v[220:223], v30, s[48:51], s8 offen sc1
    s_add_u32 s8, s8, 1024
    s_waitcnt lgkmcnt(11)
    buffer_store_dwordx4 v[224:227], v30, s[48:51], s8 offen sc1
    s_add_u32 s8, s8, 1024
    s_waitcnt lgkmcnt(9)
    buffer_store_dwordx4 v[228:231], v30, s[48:51], s8 offen sc1
    s_add_u32 s8, s8, 1024
    s_waitcnt lgkmcnt(7)
    buffer_store_dwordx4 v[232:235], v30, s[48:51], s8 offen sc1
    s_add_u32 s8, s8, 1024
    s_waitcnt lgkmcnt(5)
    buffer_store_dwordx4 v[236:239], v30, s[48:51], s8 offen sc1
    s_add_u32 s8, s8, 1024
    s_waitcnt lgkmcnt(3)
    buffer_store_dwordx4 v[240:243], v30, s[48:51], s8 offen sc1
    s_add_u32 s8, s8, 1024
    s_waitcnt lgkmcnt(1)
    buffer_store_dwordx4 v[244:247], v30, s[48:51], s8 offen sc1
    s_add_u32 s8, s8, 1024
    s_waitcnt vmcnt(0) lgkmcnt(0)
L_nc_39:
    v_readfirstlane_b32 s95, v252
    s_cmp_lg_u32 s95, 0
    s_cbranch_scc1 L_nc_40
    s_add_u32 s89, s89, 1
    s_cmp_ge_u32 s89, 400000
    s_cbranch_scc1 L_nc_40
    s_sleep 4
    global_load_dword v252, v253, s[40:41] sc1
    s_waitcnt vmcnt(0)
    s_branch L_nc_39
L_nc_40:
    v_mov_b32 v35, v252
    s_lshl_b32 s8, s88, 7
    s_mov_b64 exec, 0xff
    buffer_store_dwordx4 v[32:35], v12, s[76:79], s8 offen sc1
    s_mov_b64 exec, -1
    s_cmp_ge_u32 s2, 4
    s_cbranch_scc1 L_aux_norows
    s_lshl_b32 s8, s2, 13
    s_add_u32 s9, s8, 4096
    s_sleep 8
    buffer_load_dword v40, v2, s[76:79], s8 offen offset:12 sc1
    buffer_load_dword v41, v2, s[76:79], s8 offen offset:2060 sc1
    buffer_load_dword v42, v2, s[76:79], s9 offen offset:12 sc1
    buffer_load_dword v43, v2, s[76:79], s9 offen offset:2060 sc1
    s_waitcnt vmcnt(0)
L_all_41:
    v_cmp_ne_u32 vcc, s95, v40
    v_cmp_ne_u32 s[80:81], s95, v41
    s_or_b64 vcc, vcc, s[80:81]
    v_cmp_ne_u32 s[80:81], s95, v42
    s_or_b64 vcc, vcc, s[80:81]
    v_cmp_ne_u32 s[80:81], s95, v43
    s_or_b64 vcc, vcc, s[80:81]
    s_cmp_eq_u64 vcc, 0
    s_cbranch_scc1 L_all_42
    s_add_u32 s89, s89, 1
    s_cmp_ge_u32 s89, 400000
    s_cbranch_scc1 L_all_42
    s_sleep 8
    buffer_load_dword v40, v2, s[76:79], s8 offen offset:12 sc1
    buffer_load_dword v41, v2, s[76:79], s8 offen offset:2060 sc1
    buffer_load_dword v42, v2, s[76:79], s9 offen offset:12 sc1
    buffer_load_dword v43, v2, s[76:79], s9 offen offset:2060 sc1
    s_waitcnt vmcnt(0)
    s_branch L_all_41
L_all_42:
    s_lshl_b32 s8, s2, 7
    s_mov_b32 exec_hi, 0xff
    buffer_store_dword v252, v36, s[84:87], s8 offen sc1
    s_mov_b64 exec, -1
    s_branch L_aux_g
L_aux_norows:
    s_cmp_ge_u32 s14, 108
    s_cmov_b32 s62, 0x40000000
    s_waitcnt lgkmcnt(0)
    buffer_store_dwordx4 v[48:51], v30, s[68:71], s62 offen sc1
    s_add_u32 s62, s62, 1024
    buffer_store_dwordx4 v[52:55], v30, s[68:71], s62 offen sc1
    s_add_u32 s62, s62, 1024
    buffer_store_dwordx4 v[56:59], v30, s[68:71], s62 offen sc1
    s_add_u32 s62, s62, 1024
    buffer_store_dwordx4 v[60:63], v30, s[68:71], s62 offen sc1
    s_add_u32 s62, s62, 1024
    buffer_store_dwordx4 v[64:67], v30, s[68:71], s62 offen sc1
    s_add_u32 s62, s62, 272384
    buffer_store_dwordx4 v[68:71], v30, s[68:71], s62 offen sc1
    s_add_u32 s62, s62, 1024
    buffer_store_dwordx4 v[72:75], v30, s[68:71], s62 offen sc1
    s_add_u32 s62, s62, 1024
    buffer_store_dwordx4 v[76:79], v30, s[68:71], s62 offen sc1
    s_add_u32 s62, s62, 1024
    buffer_store_dwordx4 v[80:83], v30, s[68:71], s62 offen sc1
    s_add_u32 s62, s62, 1024
    buffer_store_dwordx4 v[84:87], v30, s[68:71], s62 offen sc1
    s_add_u32 s62, s62, 272384
    buffer_store_dwordx4 v[88:91], v30, s[68:71], s62 offen sc1
    s_add_u32 s62, s62, 1024
    buffer_store_dwordx4 v[92:95], v30, s[68:71], s62 offen sc1
    s_add_u32 s62, s62, 1024
    buffer_store_dwordx4 v[96:99], v30, s[68:71], s62 offen sc1
    s_add_u32 s62, s62, 1024
    buffer_store_dwordx4 v[100:103], v30, s[68:71], s62 offen sc1
    s_add_u32 s62, s62, 1024
    buffer_store_dwordx4 v[104:107], v30, s[68:71], s62 offen sc1
    s_add_u32 s62, s62, 272384
    buffer_store_dwordx4 v[108:111], v30, s[68:71], s62 offen sc1
    s_add_u32 s62, s62, 1024
    buffer_store_dwordx4 v[112:115], v30, s[68:71], s62 offen sc1
    s_add_u32 s62, s62, 1024
    buffer_store_dwordx4 v[116:119], v30, s[68:71], s62 offen sc1
    s_add_u32 s62, s62, 1024
    buffer_store_dwordx4 v[120:123], v30, s[68:71], s62 offen sc1
    s_add_u32 s62, s62, 1024
    buffer_store_dwordx4 v[124:127], v30, s[68:71], s62 offen sc1
    s_add_u32 s62, s62, 272384
    s_mul_i32 s8, s61, 108
    s_add_u32 s8, s8, s60
    s_lshl_b32 s8, s8, 7
    s_add_u32 s8, s8, 20480
    s_cmp_ge_u32 s14, 108
    s_cmov_b32 s8, 0x40000000
    s_add_u32 s9, s8, 6912
    s_waitcnt vmcnt(0)
L_nc_43:
    v_readfirstlane_b32 s95, v252
    s_cmp_lg_u32 s95, 0
    s_cbranch_scc1 L_nc_44
    s_add_u32 s89, s89, 1
    s_cmp_ge_u32 s89, 400000
    s_cbranch_scc1 L_nc_44
    s_sleep 4
    global_load_dword v252, v253, s[40:41] sc1
    s_waitcnt vmcnt(0)
    s_branch L_nc_43
L_nc_44:
    s_mov_b32 exec_hi, 0
    buffer_store_dword v252, v29, s[84:87], s8 offen sc1
    buffer_store_dword v252, v29, s[84:87], s9 offen sc1
    s_mov_b64 exec, -1
L_aux_g:
    s_setprio 0
    s_sub_u32 s4, s3, 4
    v_lshl_add_u32 v20, v0, 2, s4
    s_and_b32 s14, s4, 1
    s_add_u32 s14, s14, 52
    v_min_u32 v20, s14, v20
    v_lshlrev_b32 v18, 4, v0
    v_add_u32 v17, 4096, v18
    v_lshlrev_b32 v20, 7, v20
    s_lshr_b32 s14, s91, 1
    s_mul_i32 s14, s14, 6912
    s_add_u32 s14, s14, 20480
    s_add_u32 s64, s42, 5885952
    s_addc_u32 s65, s43, 0
    s_mov_b32 s66, 7077888
    s_mov_b32 s67, 0x20000
    s_add_u32 s68, s42, 3674112
    s_addc_u32 s69, s43, 0
    s_mov_b32 s70, 2211840
    s_mov_b32 s71, 0x20000
    s_mul_i32 s76, s91, 276480
    s_mul_i32 s82, s4, 5120
    s_add_u32 s76, s76, s82
    s_mul_i32 s77, s90, 221184
    s_lshl_b32 s78, s4, 12
    s_add_u32 s77, s77, s78
    s_add_u32 s82, s82, 43008
    v_and_b32 v10, 15, v0
    v_lshrrev_b32 v11, 4, v0
    v_mul_u32_u24 v12, 1280, v10
    v_mul_u32_u24 v15, 40, v11
    v_add_u32 v12, v12, v15
    s_lshl2_add_u32 s20, s90, s4
    s_mul_i32 s20, s20, 20480
    s_mul_i32 s23, s91, 160
    s_add_u32 s20, s20, s23
    s_add_u32 s18, s4, 0
    s_and_b32 s18, s18, 3
    s_lshl_b32 s18, s18, 10
    v_add_u32 v2, s18, v18
    s_add_u32 s18, s4, 1
    s_and_b32 s18, s18, 3
    s_lshl_b32 s18, s18, 10
    v_add_u32 v3, s18, v18
    s_add_u32 s18, s4, 2
    s_and_b32 s18, s18, 3
    s_lshl_b32 s18, s18, 10
    v_add_u32 v4, s18, v18
    s_add_u32 s18, s4, 3
    s_and_b32 s18, s18, 3
    s_lshl_b32 s18, s18, 10
    v_add_u32 v5, s18, v18
    v_add_u32 v6, s82, v18
    v_add_u32 v7, 61440, v6
    s_lshr_b32 s18, s90, 1
    s_mul_i32 s18, s18, 6912
    s_add_u32 s18, s18, 48128
    v_min_u32 v9, 19, v0
    v_lshlrev_b32 v9, 2, v9
    s_lshr_b32 s19, s90, 4
    s_lshl3_add_u32 s19, s19, s91
    s_lshl2_add_u32 s19, s19, s4
    s_lshl_b32 s19, s19, 7
    s_add_u32 s19, s19, 158720
    s_lshl2_add_u32 s21, s91, s4
    s_mul_i32 s21, s21, 84480
    s_lshl_b32 s23, s90, 7
    s_add_u32 s21, s21, s23
    v_lshrrev_b32 v14, 3, v0
    v_and_b32 v15, 2, v14
    s_and_b32 s23, s4, 1
    s_lshl_b32 s23, s23, 2
    v_or_b32 v15, s23, v15
    v_and_b32 v16, 7, v0
    v_xor_b32 v15, v15, v16
    v_mul_u32_u24 v14, 4224, v14
    v_lshl_add_u32 v14, v15, 4, v14
    v_lshrrev_b32 v15, 2, v10
    v_lshrrev_b32 v16, 1, v15
    v_and_b32 v21, 1, v11
    v_lshl_add_u32 v16, v21, 1, v16
    v_xor_b32 v16, s4, v16
    v_lshlrev_b32 v15, 7, v15
    v_lshl_add_u32 v15, v16, 5, v15
    v_and_b32 v16, 3, v0
    v_lshl_add_u32 v15, v16, 3, v15
    v_mul_u32_u24 v16, 5120, v11
    v_add_u32 v15, v15, v16
    v_add_u32 v15, 104448, v15
    s_sub_u32 s23, s4, 1
    s_and_b32 s23, s23, 3
    s_mul_i32 s23, s23, 5120
    s_add_u32 s23, s23, 43008
    v_add_u32 v25, s23, v18
    s_sub_u32 s23, s4, 2
    s_and_b32 s23, s23, 3
    s_mul_i32 s23, s23, 5120
    s_add_u32 s23, s23, 63488
    v_add_u32 v26, s23, v18
    s_sub_u32 s23, s4, 3
    s_and_b32 s23, s23, 3
    s_mul_i32 s23, s23, 5120
    s_add_u32 s23, s23, 83968
    v_add_u32 v27, s23, v18
    s_mov_b32 s22, 0xffff0000
    v_mul_u32_u24 v10, 160, v10
    v_mul_u32_u24 v11, 40, v11
    s_add_u32 s23, s82, 81920
    v_add3_u32 v10, v10, v11, s23
    v_mul_u32_u24 v11, 6554, v0
    v_lshrrev_b32 v11, 16, v11
    v_mul_u32_u24 v11, 1120, v11
    v_add_u32 v11, v11, v18
    s_mov_b32 s44, s16
    s_mov_b32 s45, s17
    s_mov_b32 s46, 2621440
    s_mov_b32 s47, 0x20000
    v_and_b32 v16, 1, v0
    v_lshlrev_b32 v16, 2, v16
    v_add_u32 v16, 42560, v16
    ds_read_b32 v21, v16
    s_waitcnt lgkmcnt(0)
L_gw_45:
    v_cmp_ne_u32 vcc, s95, v21
    s_cmp_eq_u64 vcc, 0
    s_cbranch_scc1 L_gw_46
    s_add_u32 s89, s89, 1
    s_cmp_ge_u32 s89, 400000
    s_cbranch_scc1 L_gw_46
    s_sleep 6
    ds_read_b32 v21, v16
    s_waitcnt lgkmcnt(0)
    s_branch L_gw_45
L_gw_46:
    buffer_load_dwordx4 v[196:199], v12, s[44:47], s20 offen
    buffer_load_dwordx4 v[200:203], v12, s[44:47], s20 offen offset:16
    buffer_load_dwordx2 v[204:205], v12, s[44:47], s20 offen offset:32
    buffer_load_dword v24, v20, s[84:87], s14 offen sc1
    s_waitcnt vmcnt(0)
    v_lshlrev_b32 v176, 16, v196
    v_and_b32 v177, s22, v196
    v_lshlrev_b32 v178, 16, v197
    v_and_b32 v179, s22, v197
    v_lshlrev_b32 v180, 16, v198
    v_and_b32 v181, s22, v198
    v_lshlrev_b32 v182, 16, v199
    v_and_b32 v183, s22, v199
    v_lshlrev_b32 v184, 16, v200
    v_and_b32 v185, s22, v200
    v_lshlrev_b32 v186, 16, v201
    v_and_b32 v187, s22, v201
    v_lshlrev_b32 v188, 16, v202
    v_and_b32 v189, s22, v202
    v_lshlrev_b32 v190, 16, v203
    v_and_b32 v191, s22, v203
    v_lshlrev_b32 v192, 16, v204
    v_and_b32 v193, s22, v204
    v_lshlrev_b32 v194, 16, v205
    v_and_b32 v195, s22, v205
L_w2f_47:
    v_cmp_ne_u32 vcc, s95, v24
    s_cmp_eq_u64 vcc, 0
    s_cbranch_scc1 L_w2f_48
    s_add_u32 s89, s89, 1
    s_cmp_ge_u32 s89, 400000
    s_cbranch_scc1 L_w2f_48
    s_sleep 16
    buffer_load_dword v24, v20, s[84:87], s14 offen sc1
    s_waitcnt vmcnt(0)
    s_branch L_w2f_47
L_w2f_48:
    s_add_u32 s79, s76, 0
    buffer_load_dwordx4 v[28:31], v18, s[68:71], s79 offen offset:0 sc1
    buffer_load_dwordx4 v[32:35], v18, s[68:71], s79 offen offset:1024 sc1
    buffer_load_dwordx4 v[36:39], v18, s[68:71], s79 offen offset:2048 sc1
    buffer_load_dwordx4 v[40:43], v18, s[68:71], s79 offen offset:3072 sc1
    buffer_load_dwordx4 v[44:47], v17, s[68:71], s79 offen sc1
    s_add_u32 s79, s76, 20480
    buffer_load_dwordx4 v[48:51], v18, s[68:71], s79 offen offset:0 sc1
    buffer_load_dwordx4 v[52:55], v18, s[68:71], s79 offen offset:1024 sc1
    buffer_load_dwordx4 v[56:59], v18, s[68:71], s79 offen offset:2048 sc1
    buffer_load_dwordx4 v[60:63], v18, s[68:71], s79 offen offset:3072 sc1
    buffer_load_dwordx4 v[64:67], v17, s[68:71], s79 offen sc1
    s_add_u32 s79, s76, 143360
    buffer_load_dwordx4 v[68:71], v18, s[68:71], s79 offen offset:0 sc1
    buffer_load_dwordx4 v[72:75], v18, s[68:71], s79 offen offset:1024 sc1
    buffer_load_dwordx4 v[76:79], v18, s[68:71], s79 offen offset:2048 sc1
    buffer_load_dwordx4 v[80:83], v18, s[68:71], s79 offen offset:3072 sc1
    buffer_load_dwordx4 v[84:87], v17, s[68:71], s79 offen sc1
    s_add_u32 s79, s76, 163840
    buffer_load_dwordx4 v[88:91], v18, s[68:71], s79 offen offset:0 sc1
    buffer_load_dwordx4 v[92:95], v18, s[68:71], s79 offen offset:1024 sc1
    buffer_load_dwordx4 v[96:99], v18, s[68:71], s79 offen offset:2048 sc1
    buffer_load_dwordx4 v[100:103], v18, s[68:71], s79 offen offset:3072 sc1
    buffer_load_dwordx4 v[104:107], v17, s[68:71], s79 offen sc1
    s_add_u32 s79, s76, 184320
    buffer_load_dwordx4 v[108:111], v18, s[68:71], s79 offen offset:0 sc1
    buffer_load_dwordx4 v[112:115], v18, s[68:71], s79 offen offset:1024 sc1
    buffer_load_dwordx4 v[116:119], v18, s[68:71], s79 offen offset:2048 sc1
    buffer_load_dwordx4 v[120:123], v18, s[68:71], s79 offen offset:3072 sc1
    buffer_load_dwordx4 v[124:127], v17, s[68:71], s79 offen sc1
    s_add_u32 s79, s76, 40960
    buffer_load_dwordx4 v[196:199], v18, s[68:71], s79 offen offset:0 sc1
    buffer_load_dwordx4 v[200:203], v18, s[68:71], s79 offen offset:1024 sc1
    buffer_load_dwordx4 v[204:207], v18, s[68:71], s79 offen offset:2048 sc1
    buffer_load_dwordx4 v[208:211], v18, s[68:71], s79 offen offset:3072 sc1
    buffer_load_dwordx4 v[212:215], v17, s[68:71], s79 offen sc1
    s_add_u32 s79, s76, 61440
    buffer_load_dwordx4 v[216:219], v18, s[68:71], s79 offen offset:0 sc1
    buffer_load_dwordx4 v[220:223], v18, s[68:71], s79 offen offset:1024 sc1
    buffer_load_dwordx4 v[224:227], v18, s[68:71], s79 offen offset:2048 sc1
    buffer_load_dwordx4 v[228:231], v18, s[68:71], s79 offen offset:3072 sc1
    buffer_load_dwordx4 v[232:235], v17, s[68:71], s79 offen sc1
    s_add_u32 s79, s76, 81920
    buffer_load_dwordx4 v[236:239], v18, s[68:71], s79 offen offset:0 sc1
    buffer_load_dwordx4 v[240:243], v18, s[68:71], s79 offen offset:1024 sc1
    buffer_load_dwordx4 v[244:247], v18, s[68:71], s79 offen offset:2048 sc1
    buffer_load_dwordx4 v[248:251], v18, s[68:71], s79 offen offset:3072 sc1
    buffer_load_dwordx4 v[252:255], v17, s[68:71], s79 offen sc1
    s_add_u32 s79, s76, 102400
    buffer_load_dwordx4 v[128:131], v18, s[68:71], s79 offen offset:0 sc1
    buffer_load_dwordx4 v[132:135], v18, s[68:71], s79 offen offset:1024 sc1
    buffer_load_dwordx4 v[136:139], v18, s[68:71], s79 offen offset:2048 sc1
    buffer_load_dwordx4 v[140:143], v18, s[68:71], s79 offen offset:3072 sc1
    buffer_load_dwordx4 v[144:147], v17, s[68:71], s79 offen sc1
    s_add_u32 s79, s76, 122880
    buffer_load_dwordx4 v[148:151], v18, s[68:71], s79 offen offset:0 sc1
    buffer_load_dwordx4 v[152:155], v18, s[68:71], s79 offen offset:1024 sc1
    buffer_load_dwordx4 v[156:159], v18, s[68:71], s79 offen offset:2048 sc1
    buffer_load_dwordx4 v[160:163], v18, s[68:71], s79 offen offset:3072 sc1
    buffer_load_dwordx4 v[164:167], v17, s[68:71], s79 offen sc1
    s_waitcnt vmcnt(0)
    s_barrier
    ds_write_b128 v6, v[196:199] offset:0
    ds_write_b128 v6, v[200:203] offset:1024
    ds_write_b128 v6, v[204:207] offset:2048
    ds_write_b128 v6, v[208:211] offset:3072
    ds_write_b128 v6, v[212:215] offset:4096
    ds_write_b128 v6, v[216:219] offset:20480
    ds_write_b128 v6, v[220:223] offset:21504
    ds_write_b128 v6, v[224:227] offset:22528
    ds_write_b128 v6, v[228:231] offset:23552
    ds_write_b128 v6, v[232:235] offset:24576
    ds_write_b128 v6, v[236:239] offset:40960
    ds_write_b128 v6, v[240:243] offset:41984
    ds_write_b128 v6, v[244:247] offset:43008
    ds_write_b128 v6, v[248:251] offset:44032
    ds_write_b128 v6, v[252:255] offset:45056
    ds_write_b128 v7, v[128:131] offset:0
    ds_write_b128 v7, v[132:135] offset:1024
    ds_write_b128 v7, v[136:139] offset:2048
    ds_write_b128 v7, v[140:143] offset:3072
    ds_write_b128 v7, v[144:147] offset:4096
    ds_write_b128 v7, v[148:151] offset:20480
    ds_write_b128 v7, v[152:155] offset:21504
    ds_write_b128 v7, v[156:159] offset:22528
    ds_write_b128 v7, v[160:163] offset:23552
    ds_write_b128 v7, v[164:167] offset:24576
    s_branch L_g2
L_done:
L_exit:
    s_endpgm
L_code_end:
.section .rodata,"a"
.p2align 6
.amdhsa_kernel parallel_sum__ssm_conv_s4d__glu_gated_swiglu__prompt_kernel
  .amdhsa_next_free_vgpr 256
  .amdhsa_next_free_sgpr 102
  .amdhsa_accum_offset 256
  .amdhsa_group_segment_fixed_size 0
  .amdhsa_kernarg_size 112
  .amdhsa_user_sgpr_count 2
  .amdhsa_user_sgpr_kernarg_segment_ptr 1
  .amdhsa_system_sgpr_workgroup_id_x 1
.end_amdhsa_kernel
```
